```python
import torch

def _softmax(x, axis=-1):
    return torch.softmax(x, dim=axis)
def _gelu(x):
    return torch.nn.functional.gelu(x, approximate="tanh")
def _silu(x):
    return torch.nn.functional.silu(x)
def _sigmoid(x):
    return torch.sigmoid(x)
def _layernorm(x, axis=-1, eps=1e-5):
    m = x.mean(dim=axis, keepdim=True)
    v = x.var(dim=axis, keepdim=True, unbiased=False)
    return (x - m) / torch.sqrt(v + eps)
def _scatter_add(tgt, idx, src, axis=0):
    return tgt.clone().index_add_(axis, idx, src)
def _segment_sum(src, seg, n):
    out = torch.zeros((n,) + src.shape[1:], dtype=src.dtype)
    return out.index_add_(0, seg, src)
def _pad(x, pw):
    flat = tuple(v for pair in reversed(pw) for v in pair)
    return torch.nn.functional.pad(x, flat)

kernel_name = 'gated_mix__ssm_conv_h3__dense_activation_mish__prompt'

def setup_inputs():

    _w = (lambda a: (lambda t: t.to(torch.bfloat16) if t.is_floating_point() else t)(torch.as_tensor(a)))
    def _A_setup():
        B, S, D = 1, 2048, 448
        ks = 4
        return {
            "q": _w((lambda *s: torch.randn(*s, dtype=torch.bfloat16) * 0.05)(B, S, D)),
            "k": _w((lambda *s: torch.randn(*s, dtype=torch.bfloat16) * 0.4)(B, S, D)),
            "v": _w((lambda *s: torch.randn(*s, dtype=torch.bfloat16) * 0.2)(B, S, D)),
            "shift_k": _w((lambda *s: torch.randn(*s, dtype=torch.bfloat16) * 0.4)(D, ks) * 0.5),
            "ssm_k": _w((lambda *s: torch.randn(*s, dtype=torch.bfloat16) * 0.4)(D, S) * (1.0 / S ** 0.5)),
            "ssm_D": _w((lambda *s: torch.randn(*s, dtype=torch.bfloat16) * 0.2)(D)),
        }
    _A_in = _A_setup()

    def _B_setup():
        B, S, D, F = 1, 2048, 448, 1792
        return {
            "x": _w((lambda *s: torch.randn(*s, dtype=torch.bfloat16) * 0.05)(B, S, D)),
            "w1": _w((lambda *s: torch.randn(*s, dtype=torch.bfloat16) * 3.2)(D, F) * (D ** -0.5)),
            "b1": _w((lambda *s: torch.randn(*s, dtype=torch.bfloat16) * 0.05)(F)),
            "w2": _w((lambda *s: torch.randn(*s, dtype=torch.bfloat16) * 0.05)(F, D) * (F ** -0.5)),
        }
    _B_in = _B_setup()

    return {
        "A_q": _A_in["q"],
        "A_k": _A_in["k"],
        "A_v": _A_in["v"],
        "A_shift_k": _A_in["shift_k"],
        "A_ssm_k": _A_in["ssm_k"],
        "A_ssm_D": _A_in["ssm_D"],
        "B_x": _B_in["x"],
        "B_w1": _B_in["w1"],
        "B_b1": _B_in["b1"],
        "B_w2": _B_in["w2"],
        "gate_w": _w((lambda *s: torch.randn(*s, dtype=torch.bfloat16) * 0.05)(448) * 16.0),
    }

def reference(A_q, A_k, A_v, A_shift_k, A_ssm_k, A_ssm_D, B_x, B_w1, B_b1, B_w2, gate_w):
    def _A_ref(q, k, v, shift_k, ssm_k, ssm_D):
        B, S, D = q.shape
        ks = shift_k.shape[-1]
        k_pad = _pad(k, ((0, 0), (ks - 1, 0), (0, 0)))
        k_shift = torch.zeros_like(k)
        for t in range(ks):
            k_shift = k_shift + k_pad[:, t:t + S, :] * shift_k[:, ks - 1 - t][None, None, :]
        kv = k_shift * v
        L = 2 * S
        kv_pad = _pad(kv, ((0, 0), (0, S), (0, 0)))
        kf_pad = _pad(ssm_k, ((0, 0), (0, S)))
        kv_f = (lambda x, axes=(-2,-1): torch.fft.rfft2(x.float(), dim=axes))(kv_pad[:, None, :, :], axes=(1, 2))
        kf_f = (lambda x, axes=(-2,-1): torch.fft.rfft2(x.float(), dim=axes))(kf_pad[:, None, :], axes=(1, 2))
        kf_f = (lambda x, *d: x.permute(*d))(kf_f, 1, 2, 0)
        y_f = kv_f * kf_f[None, :, :, :]
        y = (lambda x, s, axes=(-2,-1): torch.fft.irfft2(x, s=s, dim=axes).to(torch.bfloat16))(y_f, (1, L), axes=(1, 2))[:, 0, :S, :]
        y = y + kv * ssm_D[None, None, :]
        return q * y

    def _B_ref(x, w1, b1, w2):
        h = torch.einsum("bsd,df->bsf", x, w1) + b1
        sp = torch.log1p(torch.exp(-torch.abs(h))) + torch.where(h > 0, h, torch.zeros_like(h))
        act = h * torch.tanh(sp)
        return torch.einsum("bsf,fd->bsd", act, w2)

    x = A_q
    g = _sigmoid((x * gate_w).sum(-1, keepdims=True))
    a = _A_ref(x, A_k, A_v, A_shift_k, A_ssm_k, A_ssm_D)
    b = _B_ref(x, B_w1, B_b1, B_w2)
    return g * a + (1 - g) * b
```

```asm
; @launch grid=(256,1,1) block=(512,1,1) lds=163840
.amdgcn_target "amdgcn-amd-amdhsa--gfx950"
.text
.globl gated_mix__ssm_conv_h3__dense_activation_mish__prompt_kernel
.p2align 8
.type gated_mix__ssm_conv_h3__dense_activation_mish__prompt_kernel,@function
gated_mix__ssm_conv_h3__dense_activation_mish__prompt_kernel:
    s_cmp_ge_u32 s2, 256
    s_cbranch_scc1 L_end
    s_load_dwordx16 s[16:31], s[0:1], 0
    s_load_dwordx8 s[32:39], s[0:1], 64
    s_load_dwordx4 s[40:43], s[0:1], 96
    s_getpc_b64 s[98:99]
L_pc:
    s_lshr_b32 s4, s2, 3
    s_lshl_b32 s4, s4, 11
    s_and_b32 s4, s4, 0x7fff
    v_lshl_add_u32 v3, v0, 2, s4
    v_min_u32 v3, L_codeend-L_pc-4, v3
    global_load_dword v119, v3, s[98:99]
    v_lshrrev_b32 v2, 6, v0
    v_and_b32 v1, 63, v0
    s_and_b32 s4, s2, 7
    v_readfirstlane_b32 s3, v2
    s_cmp_ge_u32 s2, 224
    s_cbranch_scc1 L_helper
    s_lshr_b32 s5, s2, 3
    s_mul_i32 s6, s5, 9363
    s_lshr_b32 s6, s6, 16
    s_mul_i32 s7, s6, 7
    s_sub_u32 s15, s5, s7
    s_lshr_b32 s9, s4, 1
    s_lshl_b32 s10, s9, 2
    s_add_u32 s10, s10, s6
    s_and_b32 s5, s4, 1
    s_mul_i32 s11, s5, 7
    s_add_u32 s11, s11, s15
    s_lshl_b32 s14, s10, 1
    s_add_u32 s14, s14, s5
    s_mul_i32 s8, s6, 0
    s_mul_i32 s7, s15, 0
    s_add_u32 s8, s8, s7
    s_mul_i32 s9, s9, 1
    s_add_u32 s8, s8, s9
    s_mul_i32 s9, s5, 0
    s_add_u32 s8, s8, s9
    s_mul_i32 s9, s8, 9363
    s_lshr_b32 s9, s9, 16
    s_mul_i32 s9, s9, 7
    s_sub_u32 s94, s8, s9
    s_mul_i32 s92, s10, 114688
    s_lshl_b32 s93, s11, 8
    v_lshrrev_b32 v2, 3, v1
    s_lshl_b32 s4, s3, 4
    v_add_u32 v2, s4, v2
    v_mul_u32_u24 v2, 896, v2
    v_and_b32 v3, 7, v1
    v_lshrrev_b32 v4, 4, v1
    v_xor_b32 v3, v3, v4
    v_lshl_add_u32 v126, v3, 4, v2
    v_xor_b32 v3, 4, v3
    v_lshl_add_u32 v127, v3, 4, v2
    v_add_u32 v127, 7168, v127
    s_lshl_b32 s4, s3, 3
    v_add_u32 v2, s4, v4
    v_mul_u32_u24 v2, 3584, v2
    v_and_b32 v3, 15, v1
    v_lshlrev_b32 v5, 2, v4
    v_xor_b32 v3, v3, v5
    v_lshl_add_u32 v128, v3, 4, v2
    s_lshl_b32 s101, s3, 11
    s_lshr_b32 s13, s2, 5
    s_and_b32 s12, s2, 31
    v_lshlrev_b32 v10, 4, v1
    s_waitcnt lgkmcnt(0)
    s_mov_b32 s44, s16
    s_and_b32 s45, s17, 0xffff
    s_mov_b32 s46, 1835008
    s_mov_b32 s47, 0x00020000
    s_mov_b32 s60, s30
    s_and_b32 s61, s31, 0xffff
    s_mov_b32 s62, 1605632
    s_mov_b32 s63, 0x00020000
    s_lshl_b32 s95, s94, 7
    s_add_u32 m0, s101, 98304
    s_add_u32 s95, s95, s92
    s_mul_i32 s28, s94, 229376
    buffer_load_dwordx4 v126, s[44:47], s95 offen lds
    s_add_u32 s28, s28, s93
    s_add_u32 s94, s94, 1
    s_cmp_eq_u32 s94, 7
    s_cselect_b32 s94, 0, s94
    s_add_u32 m0, s101, 114688
    s_nop 0
    buffer_load_dwordx4 v128, s[60:63], s28 offen lds
    s_add_u32 s28, s28, 14336
    s_add_u32 m0, s101, 99328
    s_nop 0
    buffer_load_dwordx4 v127, s[44:47], s95 offen lds
    s_add_u32 m0, s101, 115712
    s_nop 0
    buffer_load_dwordx4 v128, s[60:63], s28 offen lds
    s_mov_b32 s64, s32
    s_and_b32 s65, s33, 0xffff
    s_mov_b32 s66, 3584
    s_mov_b32 s67, 0x00020000
    v_cmp_gt_u32 vcc, 32, v1
    v_lshlrev_b32 v2, 1, v1
    v_mov_b32 v3, 2147418112
    s_and_b32 s4, s3, 1
    s_lshl_b32 s4, s4, 7
    v_cndmask_b32 v2, v3, v2, vcc
    s_add_u32 s4, s4, s93
    buffer_load_ushort v88, v2, s[64:67], s4 offen
    buffer_load_ushort v92, v2, s[64:67], s4 offen offset:64
    v_and_b32 v2, 7, v0
    v_lshrrev_b32 v3, 3, v0
    s_lshl_b32 s4, s12, 6
    v_add_u32 v3, s4, v3
    v_mul_u32_u24 v3, 896, v3
    v_lshl_add_u32 v228, v2, 4, v3
    v_mov_b32 v229, 2147418112
    s_cmp_eq_u32 s12, 0
    s_cselect_b64 vcc, 0, -1
    v_subrev_u32 v230, 7168, v228
    v_cndmask_b32 v230, v229, v230, vcc
    s_lshl_b32 s4, s2, 2
    s_load_dword s100, s[26:27], s4
    s_mov_b32 s48, s18
    s_and_b32 s49, s19, 0xffff
    s_mov_b32 s50, 1835008
    s_mov_b32 s51, 0x00020000
    s_mov_b32 s52, s20
    s_and_b32 s53, s21, 0xffff
    s_mov_b32 s54, 1835008
    s_mov_b32 s55, 0x00020000
    s_mov_b32 s56, s22
    s_and_b32 s57, s23, 0xffff
    s_mov_b32 s58, 3584
    s_mov_b32 s59, 0x00020000
    s_mov_b32 s72, s42
    s_and_b32 s73, s43, 0xffff
    s_mov_b32 s74, 33554432
    s_mov_b32 s75, 0x00020000
    s_mov_b32 s76, s24
    s_and_b32 s77, s25, 0xffff
    s_mov_b32 s78, 1835008
    s_mov_b32 s79, 0x00020000
    s_mov_b32 s84, s38
    s_and_b32 s85, s39, 0xffff
    s_mov_b32 s86, 1835008
    s_mov_b32 s87, 0x00020000
    s_mov_b32 s88, s40
    s_and_b32 s89, s41, 0xffff
    s_mov_b32 s90, 256
    s_mov_b32 s91, 0x00020000
    s_mov_b32 s80, s34
    s_and_b32 s81, s35, 0xffff
    s_mov_b32 s82, 1605632
    s_mov_b32 s83, 0x00020000
    s_mov_b32 s68, s42
    s_and_b32 s69, s43, 0xffff
    s_mov_b32 s70, 33554432
    s_mov_b32 s71, 0x00020000
    s_mov_b32 s19, 20000
    s_or_b32 s4, s2, s3
    s_cmp_lg_u32 s4, 0
    s_cbranch_scc1 L_nononce
    s_memrealtime s[96:97]
    s_waitcnt lgkmcnt(0)
    s_or_b32 s96, s96, 1
    v_mov_b32 v2, s96
    v_mov_b32 v3, s97
    v_lshlrev_b32 v4, 8, v1
    buffer_store_dwordx2 v[2:3], v4, s[88:91], 0 offen sc1
L_nononce:
    s_lshl_b32 s8, s13, 7
    s_cmp_ge_u32 s3, 2
    s_cbranch_scc1 L_sm_1
    s_cmp_eq_u32 s3, 1
    s_cbranch_scc1 L_sm1_2
    s_mov_b32 m0, 141376
    s_nop 0
    buffer_load_dwordx4 v230, s[48:51], s8 offen lds
    s_branch L_sm_1
L_sm1_2:
    s_mov_b32 m0, 158784
    s_lshl_b32 s9, s13, 9
    buffer_load_dwordx4 v10, s[56:59], s9 offen lds
L_sm_1:
    s_lshl_b32 s9, s3, 10
    s_add_u32 m0, s9, 142400
    s_nop 0
    buffer_load_dwordx4 v228, s[48:51], s8 offen nt lds
    buffer_load_dwordx4 v[208:211], v228, s[52:55], s8 offen nt
    s_lshl_b32 s95, s94, 7
    s_add_u32 m0, s101, 0
    s_add_u32 s95, s95, s92
    s_mul_i32 s28, s94, 229376
    buffer_load_dwordx4 v126, s[44:47], s95 offen lds
    s_add_u32 s28, s28, s93
    s_add_u32 s94, s94, 1
    s_cmp_eq_u32 s94, 7
    s_cselect_b32 s94, 0, s94
    s_add_u32 m0, s101, 16384
    s_nop 0
    buffer_load_dwordx4 v128, s[60:63], s28 offen lds
    s_add_u32 s28, s28, 14336
    s_add_u32 m0, s101, 1024
    s_nop 0
    buffer_load_dwordx4 v127, s[44:47], s95 offen lds
    s_add_u32 m0, s101, 17408
    s_nop 0
    buffer_load_dwordx4 v128, s[60:63], s28 offen lds
    s_lshr_b32 s4, s3, 1
    s_lshl_b32 s4, s4, 5
    v_and_b32 v2, 31, v1
    v_add_u32 v2, s4, v2
    v_lshrrev_b32 v3, 5, v1
    v_bfe_u32 v4, v2, 1, 3
    v_xor_b32 v3, v3, v4
    v_lshlrev_b32 v3, 4, v3
    v_lshl_add_u32 v129, v2, 7, v3
    v_xor_b32 v130, 32, v129
    v_xor_b32 v131, 64, v129
    v_xor_b32 v132, 0x60, v129
    v_add_u32 v133, 0x10000, v129
    v_add_u32 v134, 0x10000, v130
    v_add_u32 v135, 0x10000, v131
    v_add_u32 v136, 0x10000, v132
    v_bfe_u32 v2, v1, 4, 1
    v_lshrrev_b32 v3, 5, v1
    v_bfe_u32 v4, v1, 2, 2
    v_and_b32 v5, 3, v1
    v_lshl_add_u32 v6, v3, 3, v4
    v_lshlrev_b32 v6, 8, v6
    s_and_b32 s4, s3, 1
    s_lshl_b32 s4, s4, 3
    v_lshl_add_u32 v2, v2, 1, s4
    v_lshrrev_b32 v3, 1, v5
    v_add_u32 v2, v2, v3
    v_lshlrev_b32 v3, 2, v4
    v_xor_b32 v2, v2, v3
    v_lshl_add_u32 v6, v2, 4, v6
    v_and_b32 v5, 1, v5
    v_lshl_add_u32 v137, v5, 3, v6
    v_xor_b32 v138, 64, v137
    v_add_u32 v139, 0x10000, v137
    v_add_u32 v140, 0x10000, v138
    v_mov_b32 v89, 0
    v_mov_b32 v90, 0
    v_mov_b32 v91, 0
    v_mov_b32 v93, 0
    v_mov_b32 v94, 0x3f80
    v_mov_b32 v95, 0
    v_mov_b32 v96, 0x3f80
    v_mov_b32 v97, 0
    s_mov_b32 s16, 0x05040100
    s_mov_b32 s17, 0x07060302
    v_lshlrev_b32 v2, 4, v0
    v_add_u32 v108, 142016, v2
    v_and_b32 v3, 7, v0
    v_lshlrev_b32 v4, 6, v3
    v_add_u32 v109, 158784, v4
    v_lshrrev_b32 v2, 3, v0
    v_sub_u32 v2, 63, v2
    v_bfe_u32 v4, v2, 1, 1
    v_bfe_u32 v5, v2, 3, 2
    v_lshl_add_u32 v4, v5, 1, v4
    v_xor_b32 v3, v3, v4
    v_lshlrev_b32 v3, 4, v3
    v_lshl_add_u32 v2, v2, 7, v3
    v_add_u32 v110, 150592, v2
    v_bfe_u32 v2, v1, 2, 2
    v_and_b32 v3, 3, v1
    v_lshl_add_u32 v4, v3, 3, v2
    v_lshrrev_b32 v2, 1, v2
    v_lshl_add_u32 v2, v3, 1, v2
    s_and_b32 s5, s3, 3
    s_lshl_b32 s6, s5, 1
    v_lshrrev_b32 v3, 5, v1
    v_add_u32 v3, s6, v3
    v_xor_b32 v2, v2, v3
    v_lshlrev_b32 v2, 4, v2
    v_lshl_add_u32 v2, v4, 7, v2
    v_bfe_u32 v3, v1, 4, 1
    v_lshl_add_u32 v2, v3, 3, v2
    s_lshr_b32 s4, s3, 2
    s_lshl_b32 s6, s4, 12
    s_add_u32 s6, s6, 150592
    v_add_u32 v111, s6, v2
    v_lshrrev_b32 v2, 4, v1
    v_bfe_u32 v3, v1, 1, 1
    v_lshl_add_u32 v2, v2, 1, v3
    v_bfe_u32 v3, v1, 2, 2
    v_and_b32 v4, 1, v1
    v_lshl_add_u32 v3, v3, 1, v4
    v_lshlrev_b32 v3, 4, v3
    v_lshl_add_u32 v112, v2, 13, v3
    s_lshl_b32 s6, s13, 2
    s_add_u32 s6, s6, s5
    s_lshl_b32 s6, s6, 16
    s_lshl_b32 s4, s4, 7
    s_add_u32 s6, s6, s4
    s_lshl_b32 s4, s12, 8
    s_sub_u32 s6, s6, s4
    s_add_u32 s22, s6, 8396544
    s_mul_i32 s4, s10, 28
    s_lshl_b32 s5, s11, 1
    s_add_u32 s4, s4, s5
    s_and_b32 s5, s3, 1
    s_add_u32 s4, s4, s5
    s_lshl_b32 s4, s4, 2
    s_lshr_b32 s5, s3, 1
    s_add_u32 s4, s4, s5
    s_lshl_b32 s4, s4, 7
    s_add_u32 s24, s4, 15990784
    v_mov_b32 v2, 2147418112
    s_lshl_b32 s5, s2, 3
    v_writelane_b32 v2, s24, 0
    s_add_u32 s5, s5, s3
    s_lshl_b32 s5, s5, 7
    s_add_u32 s25, s5, 16252928
    v_writelane_b32 v2, s25, 1
    s_add_u32 s23, s5, 15728640
    v_writelane_b32 v2, s23, 2
    buffer_load_dword v118, v2, s[72:75], 0 offen sc1
    v_cmp_gt_u32 vcc, 16, v1
    v_mov_b32 v4, 2147418112
    v_lshlrev_b32 v5, 3, v1
    v_cndmask_b32 v28, v4, v5, vcc
    v_mov_b32 v4, 0
    v_mov_b32 v5, 0
    v_mov_b32 v6, 0
    v_mov_b32 v7, 0
    v_min_u32 v2, 29, v1
    v_lshlrev_b32 v2, 4, v2
    v_add_u32 v2, 132160, v2
    ds_write_b128 v2, v[4:7]
    ds_write_b128 v2, v[4:7] offset:4608
    s_and_b32 s4, s10, 3
    s_add_u32 s4, s4, s15
    s_mul_i32 s5, s4, 11
    s_lshr_b32 s5, s5, 5
    s_mul_i32 s5, s5, 3
    s_sub_u32 s5, s4, s5
    s_and_b32 s4, s4, 3
    s_lshl_b32 s4, s4, 2
    s_lshl_b32 s5, s5, 2
    s_lshr_b32 s4, 0x64206420, s4
    s_and_b32 s4, s4, 0xffff
    s_lshr_b32 s5, 0x531531, s5
    s_and_b32 s5, s5, 0xfff
    s_lshl_b32 s6, s5, 16
    s_or_b32 s6, s6, s4
    s_lshl_b32 s7, s4, 12
    s_or_b32 s7, s7, s5
    s_bitcmp1_b32 s3, 0
    s_cselect_b32 s37, s7, s6
    v_lshrrev_b32 v2, 5, v1
    v_bfe_u32 v3, v1, 4, 1
    v_lshlrev_b32 v2, 4, v2
    v_lshl_add_u32 v2, v3, 2, v2
    v_bfe_u32 v3, v1, 3, 1
    v_lshl_add_u32 v2, v3, 3, v2
    v_mul_u32_u24 v2, 896, v2
    v_and_b32 v3, 7, v1
    v_lshl_add_u32 v11, v3, 4, v2
    s_mul_i32 s5, s3, 200704
    s_lshl_b32 s4, s15, 7
    s_add_u32 s5, s5, s4
    s_bfe_u32 s4, s37, 262144
    s_mul_i32 s4, s4, 28672
    s_add_u32 s55, s4, s5
    s_bfe_u32 s4, s37, 262148
    s_mul_i32 s4, s4, 28672
    s_add_u32 s56, s4, s5
    s_bfe_u32 s4, s37, 262152
    s_mul_i32 s4, s4, 28672
    s_add_u32 s57, s4, s5
    s_bfe_u32 s4, s37, 262156
    s_mul_i32 s4, s4, 28672
    s_add_u32 s58, s4, s5
    s_bfe_u32 s4, s37, 262160
    s_mul_i32 s4, s4, 28672
    s_add_u32 s59, s4, s5
    s_bfe_u32 s4, s37, 262164
    s_mul_i32 s4, s4, 28672
    s_add_u32 s64, s4, s5
    s_bfe_u32 s4, s37, 262168
    s_mul_i32 s4, s4, 28672
    s_add_u32 s65, s4, s5
    s_lshl_b32 s95, s94, 7
    s_add_u32 m0, s101, 32768
    s_add_u32 s95, s95, s92
    s_mul_i32 s28, s94, 229376
    buffer_load_dwordx4 v126, s[44:47], s95 offen lds
    s_add_u32 s28, s28, s93
    s_add_u32 s94, s94, 1
    s_cmp_eq_u32 s94, 7
    s_cselect_b32 s94, 0, s94
    s_add_u32 m0, s101, 49152
    s_nop 0
    buffer_load_dwordx4 v128, s[60:63], s28 offen lds
    s_add_u32 s28, s28, 14336
    s_add_u32 m0, s101, 33792
    s_nop 0
    buffer_load_dwordx4 v127, s[44:47], s95 offen lds
    s_add_u32 m0, s101, 50176
    s_nop 0
    buffer_load_dwordx4 v128, s[60:63], s28 offen lds
    s_waitcnt vmcnt(13)
    s_waitcnt vmcnt(11)
    v_mfma_f32_32x32x16_bf16 v[32:47], v[88:91], v[94:97], 0
    v_mfma_f32_32x32x16_bf16 v[48:63], v[90:93], v[94:97], 0
    s_waitcnt vmcnt(9)
    s_waitcnt lgkmcnt(0)
    s_barrier
    ds_read_b128 v[72:75], v133 offset:32768
    ds_read_b64_tr_b16 v[64:65], v139 offset:49152
    ds_read_b64_tr_b16 v[66:67], v139 offset:50176
    ds_read_b64_tr_b16 v[68:69], v140 offset:49152
    ds_read_b64_tr_b16 v[70:71], v140 offset:50176
    ds_read_b128 v[84:87], v134 offset:32768
    ds_read_b64_tr_b16 v[76:77], v139 offset:53248
    ds_read_b64_tr_b16 v[78:79], v139 offset:54272
    ds_read_b64_tr_b16 v[80:81], v140 offset:53248
    ds_read_b64_tr_b16 v[82:83], v140 offset:54272
    s_waitcnt lgkmcnt(5)
    v_mfma_f32_32x32x16_bf16 v[32:47], v[64:67], v[72:75], v[32:47]
    ds_read_b128 v[96:99], v135 offset:32768
    ds_read_b64_tr_b16 v[88:89], v139 offset:57344
    ds_read_b64_tr_b16 v[90:91], v139 offset:58368
    ds_read_b64_tr_b16 v[92:93], v140 offset:57344
    ds_read_b64_tr_b16 v[94:95], v140 offset:58368
    ds_read_b128 v[192:195], v108 offset:384
    ds_read_b128 v[196:199], v108 offset:256
    ds_read_b128 v[200:203], v108 offset:128
    ds_read_b128 v[204:207], v108 offset:0
    v_mfma_f32_32x32x16_bf16 v[48:63], v[68:71], v[72:75], v[48:63]
    s_lshl_b32 s95, s94, 7
    s_add_u32 m0, s101, 65536
    s_add_u32 s95, s95, s92
    s_mul_i32 s28, s94, 229376
    buffer_load_dwordx4 v126, s[44:47], s95 offen lds
    s_add_u32 s28, s28, s93
    s_add_u32 s94, s94, 1
    s_cmp_eq_u32 s94, 7
    s_cselect_b32 s94, 0, s94
    s_add_u32 m0, s101, 81920
    s_nop 0
    buffer_load_dwordx4 v128, s[60:63], s28 offen lds
    s_add_u32 s28, s28, 14336
    s_waitcnt lgkmcnt(9)
    v_mfma_f32_32x32x16_bf16 v[32:47], v[76:79], v[84:87], v[32:47]
    ds_read_b128 v[72:75], v136 offset:32768
    ds_read_b64_tr_b16 v[64:65], v139 offset:61440
    ds_read_b64_tr_b16 v[66:67], v139 offset:62464
    ds_read_b64_tr_b16 v[68:69], v140 offset:61440
    ds_read_b64_tr_b16 v[70:71], v140 offset:62464
    ds_read_b128 v[212:215], v109 offset:0
    ds_read_b128 v[216:219], v109 offset:16
    ds_read_b128 v[220:223], v109 offset:32
    ds_read_b128 v[224:227], v109 offset:48
    v_mfma_f32_32x32x16_bf16 v[48:63], v[80:83], v[84:87], v[48:63]
    s_add_u32 m0, s101, 66560
    s_nop 0
    buffer_load_dwordx4 v127, s[44:47], s95 offen lds
    s_add_u32 m0, s101, 82944
    s_nop 0
    buffer_load_dwordx4 v128, s[60:63], s28 offen lds
    s_waitcnt lgkmcnt(9)
    v_perm_b32 v228, v196, v192, s16
    v_perm_b32 v229, v196, v192, s17
    v_mfma_f32_32x32x16_bf16 v[32:47], v[88:91], v[96:99], v[32:47]
    s_waitcnt lgkmcnt(0)
    s_waitcnt vmcnt(9)
    s_barrier
    ds_read_b128 v[84:87], v129 offset:0
    ds_read_b64_tr_b16 v[76:77], v137 offset:16384
    ds_read_b64_tr_b16 v[78:79], v137 offset:17408
    ds_read_b64_tr_b16 v[80:81], v138 offset:16384
    ds_read_b64_tr_b16 v[82:83], v138 offset:17408
    v_perm_b32 v230, v204, v200, s16
    v_perm_b32 v231, v204, v200, s17
    v_perm_b32 v232, v197, v193, s16
    v_perm_b32 v233, v197, v193, s17
    v_mfma_f32_32x32x16_bf16 v[48:63], v[92:95], v[96:99], v[48:63]
    s_lshl_b32 s95, s94, 7
    s_add_u32 m0, s101, 98304
    s_add_u32 s95, s95, s92
    s_mul_i32 s28, s94, 229376
    buffer_load_dwordx4 v126, s[44:47], s95 offen lds
    s_add_u32 s28, s28, s93
    s_add_u32 s94, s94, 1
    s_cmp_eq_u32 s94, 7
    s_cselect_b32 s94, 0, s94
    v_mfma_f32_32x32x16_bf16 v[32:47], v[64:67], v[72:75], v[32:47]
    ds_read_b128 v[96:99], v130 offset:0
    ds_read_b64_tr_b16 v[88:89], v137 offset:20480
    ds_read_b64_tr_b16 v[90:91], v137 offset:21504
    ds_read_b64_tr_b16 v[92:93], v138 offset:20480
    ds_read_b64_tr_b16 v[94:95], v138 offset:21504
    v_perm_b32 v234, v205, v201, s16
    v_perm_b32 v235, v205, v201, s17
    v_perm_b32 v236, v198, v194, s16
    v_perm_b32 v237, v198, v194, s17
    v_mfma_f32_32x32x16_bf16 v[48:63], v[68:71], v[72:75], v[48:63]
    s_add_u32 m0, s101, 114688
    s_nop 0
    buffer_load_dwordx4 v128, s[60:63], s28 offen lds
    s_add_u32 s28, s28, 14336
    v_perm_b32 v238, v206, v202, s16
    v_perm_b32 v239, v206, v202, s17
    v_perm_b32 v240, v199, v195, s16
    v_perm_b32 v241, v199, v195, s17
    s_waitcnt lgkmcnt(5)
    v_mfma_f32_32x32x16_bf16 v[32:47], v[76:79], v[84:87], v[32:47]
    ds_read_b128 v[72:75], v131 offset:0
    ds_read_b64_tr_b16 v[64:65], v137 offset:24576
    ds_read_b64_tr_b16 v[66:67], v137 offset:25600
    ds_read_b64_tr_b16 v[68:69], v138 offset:24576
    ds_read_b64_tr_b16 v[70:71], v138 offset:25600
    v_perm_b32 v242, v207, v203, s16
    v_perm_b32 v243, v207, v203, s17
    v_dot2_f32_bf16 v192, v228, v212, 0
    v_dot2_f32_bf16 v193, v229, v214, 0
    v_mfma_f32_32x32x16_bf16 v[48:63], v[80:83], v[84:87], v[48:63]
    s_add_u32 m0, s101, 99328
    s_nop 0
    buffer_load_dwordx4 v127, s[44:47], s95 offen lds
    v_dot2_f32_bf16 v194, v232, v216, 0
    v_dot2_f32_bf16 v195, v233, v218, 0
    v_dot2_f32_bf16 v196, v236, v220, 0
    v_dot2_f32_bf16 v197, v237, v222, 0
    v_dot2_f32_bf16 v198, v240, v224, 0
    s_waitcnt lgkmcnt(5)
    v_mfma_f32_32x32x16_bf16 v[32:47], v[88:91], v[96:99], v[32:47]
    ds_read_b128 v[84:87], v132 offset:0
    ds_read_b64_tr_b16 v[76:77], v137 offset:28672
    ds_read_b64_tr_b16 v[78:79], v137 offset:29696
    ds_read_b64_tr_b16 v[80:81], v138 offset:28672
    ds_read_b64_tr_b16 v[82:83], v138 offset:29696
    v_dot2_f32_bf16 v199, v241, v226, 0
    v_dot2_f32_bf16 v192, v230, v213, v192
    v_dot2_f32_bf16 v193, v231, v215, v193
    v_dot2_f32_bf16 v194, v234, v217, v194
    v_mfma_f32_32x32x16_bf16 v[48:63], v[92:95], v[96:99], v[48:63]
    s_add_u32 m0, s101, 115712
    s_nop 0
    buffer_load_dwordx4 v128, s[60:63], s28 offen lds
    v_dot2_f32_bf16 v195, v235, v219, v195
    v_dot2_f32_bf16 v196, v238, v221, v196
    v_dot2_f32_bf16 v197, v239, v223, v197
    v_dot2_f32_bf16 v198, v242, v225, v198
    v_dot2_f32_bf16 v199, v243, v227, v199
    s_waitcnt lgkmcnt(5)
    v_mfma_f32_32x32x16_bf16 v[32:47], v[64:67], v[72:75], v[32:47]
    v_lshlrev_b32 v200, 16, v208
    v_and_b32 v201, 0xffff0000, v208
    v_lshlrev_b32 v202, 16, v209
    v_and_b32 v203, 0xffff0000, v209
    v_lshlrev_b32 v204, 16, v210
    v_and_b32 v205, 0xffff0000, v210
    v_lshlrev_b32 v206, 16, v211
    v_and_b32 v207, 0xffff0000, v211
    v_mul_f32 v192, v192, v200
    v_mul_f32 v193, v193, v201
    v_mul_f32 v194, v194, v202
    v_mul_f32 v195, v195, v203
    v_mul_f32 v196, v196, v204
    v_mul_f32 v197, v197, v205
    v_mul_f32 v198, v198, v206
    v_mul_f32 v199, v199, v207
    v_cvt_pk_bf16_f32 v248, v192, v193
    v_cvt_pk_bf16_f32 v249, v194, v195
    v_cvt_pk_bf16_f32 v250, v196, v197
    v_cvt_pk_bf16_f32 v251, v198, v199
    ds_write_b128 v110, v[248:251]
    s_waitcnt lgkmcnt(0)
    s_waitcnt vmcnt(8)
    s_barrier
    ds_read_b64_tr_b16 v[252:253], v111
    ds_read_b64_tr_b16 v[254:255], v111 offset:512
    ds_read_b128 v[96:99], v129 offset:32768
    ds_read_b64_tr_b16 v[88:89], v137 offset:49152
    ds_read_b64_tr_b16 v[90:91], v137 offset:50176
    ds_read_b64_tr_b16 v[92:93], v138 offset:49152
    ds_read_b64_tr_b16 v[94:95], v138 offset:50176
    s_lshr_b32 s5, s3, 2
    s_and_b32 s6, s3, 3
    s_mul_i32 s7, s5, 4608
    s_lshl_b32 s6, s6, 10
    v_mfma_f32_32x32x16_bf16 v[48:63], v[68:71], v[72:75], v[48:63]
    s_lshl_b32 s95, s94, 7
    s_add_u32 m0, s101, 0
    s_add_u32 s95, s95, s92
    s_mul_i32 s28, s94, 229376
    buffer_load_dwordx4 v126, s[44:47], s95 offen lds
    s_add_u32 s28, s28, s93
    s_add_u32 s94, s94, 1
    s_cmp_eq_u32 s94, 7
    s_cselect_b32 s94, 0, s94
    s_waitcnt lgkmcnt(5)
    buffer_store_dwordx4 v[252:255], v112, s[72:75], s22 offen sc1
    buffer_load_dwordx2 v[30:31], off, s[88:91], 0 sc1
    v_mfma_f32_32x32x16_bf16 v[32:47], v[76:79], v[84:87], v[32:47]
    ds_read_b128 v[72:75], v130 offset:32768
    ds_read_b64_tr_b16 v[64:65], v137 offset:53248
    ds_read_b64_tr_b16 v[66:67], v137 offset:54272
    ds_read_b64_tr_b16 v[68:69], v138 offset:53248
    ds_read_b64_tr_b16 v[70:71], v138 offset:54272
    s_add_u32 s7, s7, s6
    s_add_u32 s27, s7, 132640
    s_lshl_b32 s4, s2, 13
    s_lshl_b32 s7, s3, 10
    v_mfma_f32_32x32x16_bf16 v[48:63], v[80:83], v[84:87], v[48:63]
    s_add_u32 m0, s101, 16384
    s_nop 0
    buffer_load_dwordx4 v128, s[60:63], s28 offen lds
    s_add_u32 s28, s28, 14336
    s_add_u32 s29, s4, s7
    s_lshl_b32 s4, s3, 2
    s_sub_u32 s4, 31, s4
    v_lshrrev_b32 v2, 1, v1
    s_waitcnt lgkmcnt(5)
    v_mfma_f32_32x32x16_bf16 v[32:47], v[88:91], v[96:99], v[32:47]
    ds_read_b128 v[84:87], v131 offset:32768
    ds_read_b64_tr_b16 v[76:77], v137 offset:57344
    ds_read_b64_tr_b16 v[78:79], v137 offset:58368
    ds_read_b64_tr_b16 v[80:81], v138 offset:57344
    ds_read_b64_tr_b16 v[82:83], v138 offset:58368
    v_min_u32 v2, 4, v2
    v_sub_u32 v2, s4, v2
    v_max_i32 v2, 0, v2
    v_and_b32 v3, 1, v1
    v_mfma_f32_32x32x16_bf16 v[48:63], v[92:95], v[96:99], v[48:63]
    s_add_u32 m0, s101, 1024
    s_nop 0
    buffer_load_dwordx4 v127, s[44:47], s95 offen lds
    v_lshlrev_b32 v3, 2, v3
    v_lshl_add_u32 v2, v2, 3, v3
    s_lshl_b32 s5, s13, 8
    s_lshr_b32 s6, s12, 3
    s_add_u32 s5, s5, s6
    s_waitcnt lgkmcnt(5)
    v_mfma_f32_32x32x16_bf16 v[32:47], v[64:67], v[72:75], v[32:47]
    ds_read_b128 v[96:99], v132 offset:32768
    ds_read_b64_tr_b16 v[88:89], v137 offset:61440
    ds_read_b64_tr_b16 v[90:91], v137 offset:62464
    ds_read_b64_tr_b16 v[92:93], v138 offset:61440
    ds_read_b64_tr_b16 v[94:95], v138 offset:62464
    s_lshl_b32 s5, s5, 7
    s_add_u32 s5, s5, 15728640
    v_lshl_add_u32 v113, v2, 7, s5
    v_lshrrev_b32 v2, 1, v0
    v_mfma_f32_32x32x16_bf16 v[48:63], v[68:71], v[72:75], v[48:63]
    s_add_u32 m0, s101, 17408
    s_nop 0
    buffer_load_dwordx4 v128, s[60:63], s28 offen lds
    v_and_b32 v3, 1, v0
    v_lshlrev_b32 v114, 4, v0
    v_cmp_ne_u32 vcc, 255, v2
    v_add_u32 v4, 32, v114
    v_mov_b32 v5, 2147418112
    s_waitcnt lgkmcnt(5)
    v_mfma_f32_32x32x16_bf16 v[32:47], v[76:79], v[84:87], v[32:47]
    s_waitcnt lgkmcnt(0)
    s_waitcnt vmcnt(10)
    s_barrier
    ds_read_b128 v[72:75], v133 offset:0
    ds_read_b64_tr_b16 v[64:65], v139 offset:16384
    ds_read_b64_tr_b16 v[66:67], v139 offset:17408
    ds_read_b64_tr_b16 v[68:69], v140 offset:16384
    ds_read_b64_tr_b16 v[70:71], v140 offset:17408
    v_cndmask_b32 v115, v5, v4, vcc
    s_lshl_b32 s4, s2, 13
    s_add_u32 s26, s4, 8388608
    v_mul_u32_u24 v3, 33344, v3
    v_mfma_f32_32x32x16_bf16 v[48:63], v[80:83], v[84:87], v[48:63]
    s_lshl_b32 s95, s94, 7
    s_add_u32 m0, s101, 32768
    s_add_u32 s95, s95, s92
    s_mul_i32 s28, s94, 229376
    buffer_load_dwordx4 v126, s[44:47], s95 offen lds
    s_add_u32 s28, s28, s93
    s_add_u32 s94, s94, 1
    s_cmp_eq_u32 s94, 7
    s_cselect_b32 s94, 0, s94
    v_mfma_f32_32x32x16_bf16 v[32:47], v[88:91], v[96:99], v[32:47]
    ds_read_b128 v[84:87], v134 offset:0
    ds_read_b64_tr_b16 v[76:77], v139 offset:20480
    ds_read_b64_tr_b16 v[78:79], v139 offset:21504
    ds_read_b64_tr_b16 v[80:81], v140 offset:20480
    ds_read_b64_tr_b16 v[82:83], v140 offset:21504
    v_lshl_add_u32 v2, v2, 4, v3
    v_add_u32 v142, 65536, v2
    s_lshr_b32 s5, s3, 2
    s_and_b32 s6, s3, 3
    v_mfma_f32_32x32x16_bf16 v[48:63], v[92:95], v[96:99], v[48:63]
    s_add_u32 m0, s101, 49152
    s_nop 0
    buffer_load_dwordx4 v128, s[60:63], s28 offen lds
    s_add_u32 s28, s28, 14336
    s_mul_i32 s7, s5, 33344
    s_mul_i32 s4, s6, 8320
    s_add_u32 s7, s7, s4
    s_add_u32 s7, s7, 69632
    s_waitcnt lgkmcnt(5)
    v_mfma_f32_32x32x16_bf16 v[32:47], v[64:67], v[72:75], v[32:47]
    ds_read_b128 v[96:99], v135 offset:0
    ds_read_b64_tr_b16 v[88:89], v139 offset:24576
    ds_read_b64_tr_b16 v[90:91], v139 offset:25600
    ds_read_b64_tr_b16 v[92:93], v140 offset:24576
    ds_read_b64_tr_b16 v[94:95], v140 offset:25600
    v_and_b32 v2, 1, v1
    v_mul_u32_u24 v2, 4160, v2
    v_add_u32 v143, s7, v2
    s_lshr_b32 s4, s3, 1
    v_mfma_f32_32x32x16_bf16 v[48:63], v[68:71], v[72:75], v[48:63]
    s_add_u32 m0, s101, 33792
    s_nop 0
    buffer_load_dwordx4 v127, s[44:47], s95 offen lds
    s_lshl_b32 s5, s10, 2
    s_add_u32 s4, s4, s5
    s_mul_i32 s4, s4, 112
    s_lshl_b32 s5, s11, 3
    s_add_u32 s4, s4, s5
    s_waitcnt lgkmcnt(5)
    v_mfma_f32_32x32x16_bf16 v[32:47], v[76:79], v[84:87], v[32:47]
    ds_read_b128 v[72:75], v136 offset:0
    ds_read_b64_tr_b16 v[64:65], v139 offset:28672
    ds_read_b64_tr_b16 v[66:67], v139 offset:29696
    ds_read_b64_tr_b16 v[68:69], v140 offset:28672
    ds_read_b64_tr_b16 v[70:71], v140 offset:29696
    s_and_b32 s5, s3, 1
    s_lshl_b32 s5, s5, 2
    s_add_u32 s4, s4, s5
    s_lshl_b32 s30, s4, 10
    v_mfma_f32_32x32x16_bf16 v[48:63], v[80:83], v[84:87], v[48:63]
    s_add_u32 m0, s101, 50176
    s_nop 0
    buffer_load_dwordx4 v128, s[60:63], s28 offen lds
    s_waitcnt vmcnt(7)
    v_readfirstlane_b32 s96, v30
    v_readfirstlane_b32 s97, v31
    s_cmp_lg_u32 s96, 0
    s_cbranch_scc1 L_nok_3
L_nre_4:
    s_cmp_eq_u32 s19, 0
    s_cbranch_scc1 L_nok_3
    s_sub_u32 s19, s19, 1
    s_sleep 2
    buffer_load_dwordx2 v[30:31], off, s[88:91], 0 sc1
    s_waitcnt vmcnt(0)
    v_readfirstlane_b32 s96, v30
    v_readfirstlane_b32 s97, v31
    s_cmp_eq_u32 s96, 0
    s_cbranch_scc1 L_nre_4
L_nok_3:
    buffer_store_dwordx2 v[30:31], v28, s[72:75], s23 offen sc1
    s_waitcnt lgkmcnt(5)
    v_mfma_f32_32x32x16_bf16 v[32:47], v[88:91], v[96:99], v[32:47]
    s_waitcnt lgkmcnt(0)
    s_barrier
    ds_read_b128 v[84:87], v133 offset:32768
    ds_read_b64_tr_b16 v[76:77], v139 offset:49152
    ds_read_b64_tr_b16 v[78:79], v139 offset:50176
    ds_read_b64_tr_b16 v[80:81], v140 offset:49152
    ds_read_b64_tr_b16 v[82:83], v140 offset:50176
    s_mov_b32 s18, 0x3fb8aa3b
    s_mov_b32 s20, 0x00ff00ff
    s_mov_b32 s21, 0x00ff00ff
    s_lshr_b32 s5, s3, 2
    v_mfma_f32_32x32x16_bf16 v[48:63], v[92:95], v[96:99], v[48:63]
    s_mov_b32 m0, s27
    s_nop 0
    buffer_load_dwordx4 v10, s[76:79], s29 offen nt lds
    buffer_load_dwordx4 v[160:163], v11, s[80:83], s55 offen offset:0
    s_bfe_u32 s6, s3, 0x10001
    s_sub_u32 s6, 1, s6
    s_lshl_b32 s6, s6, 8
    s_mul_i32 s7, s5, 33344
    v_mfma_f32_32x32x16_bf16 v[32:47], v[64:67], v[72:75], v[32:47]
    ds_read_b128 v[96:99], v134 offset:32768
    ds_read_b64_tr_b16 v[88:89], v139 offset:53248
    ds_read_b64_tr_b16 v[90:91], v139 offset:54272
    ds_read_b64_tr_b16 v[92:93], v140 offset:53248
    ds_read_b64_tr_b16 v[94:95], v140 offset:54272
    s_add_u32 s7, s7, s6
    s_add_u32 s7, s7, 65552
    v_and_b32 v2, 7, v1
    v_mul_u32_u24 v2, 4160, v2
    v_mfma_f32_32x32x16_bf16 v[48:63], v[68:71], v[72:75], v[48:63]
    buffer_load_dwordx4 v[164:167], v11, s[80:83], s55 offen offset:896
    v_bfe_u32 v3, v1, 3, 1
    v_lshrrev_b32 v4, 4, v1
    v_sub_u32 v3, v4, v3
    v_lshlrev_b32 v3, 4, v3
    v_add3_u32 v8, v2, v3, s7
    s_mul_i32 s7, s5, 4608
    s_add_u32 s7, s7, s6
    s_waitcnt lgkmcnt(5)
    v_mfma_f32_32x32x16_bf16 v[32:47], v[76:79], v[84:87], v[32:47]
    ds_read_b128 v[72:75], v135 offset:32768
    ds_read_b64_tr_b16 v[64:65], v139 offset:57344
    ds_read_b64_tr_b16 v[66:67], v139 offset:58368
    ds_read_b64_tr_b16 v[68:69], v140 offset:57344
    ds_read_b64_tr_b16 v[70:71], v140 offset:58368
    s_add_u32 s7, s7, 132160
    v_and_b32 v2, 15, v1
    v_lshlrev_b32 v2, 5, v2
    v_lshl_add_u32 v2, v4, 4, v2
    v_mfma_f32_32x32x16_bf16 v[48:63], v[80:83], v[84:87], v[48:63]
    buffer_load_dwordx4 v[168:171], v11, s[80:83], s55 offen offset:1792
    v_add_u32 v9, s7, v2
    s_mul_i32 s4, s3, 14
    s_add_u32 s5, s4, 13
    s_lshr_b32 s4, s4, 2
    s_lshr_b32 s5, s5, 2
    v_bfe_u32 v2, v1, 1, 4
    v_add_u32 v2, s4, v2
    s_waitcnt lgkmcnt(5)
    v_mfma_f32_32x32x16_bf16 v[32:47], v[88:91], v[96:99], v[32:47]
    ds_read_b128 v[84:87], v136 offset:32768
    ds_read_b64_tr_b16 v[76:77], v139 offset:61440
    ds_read_b64_tr_b16 v[78:79], v139 offset:62464
    ds_read_b64_tr_b16 v[80:81], v140 offset:61440
    ds_read_b64_tr_b16 v[82:83], v140 offset:62464
    v_min_u32 v2, s5, v2
    v_and_b32 v3, 1, v1
    v_lshl_add_u32 v2, v2, 2, v3
    s_lshr_b32 s6, s14, 1
    v_mfma_f32_32x32x16_bf16 v[48:63], v[92:95], v[96:99], v[48:63]
    buffer_load_dwordx4 v[172:175], v11, s[80:83], s55 offen offset:2688
    s_mul_i32 s6, s6, 112
    s_and_b32 s5, s14, 1
    s_lshl_b32 s5, s5, 1
    s_add_u32 s6, s6, s5
    s_add_u32 s6, s6, 124928
    v_add_u32 v2, s6, v2
    s_lshl_b32 s4, s14, 3
    s_waitcnt lgkmcnt(5)
    v_mfma_f32_32x32x16_bf16 v[32:47], v[64:67], v[72:75], v[32:47]
    s_waitcnt lgkmcnt(0)
    s_waitcnt vmcnt(10)
    s_barrier
    ds_read_b128 v[96:99], v129 offset:0
    ds_read_b64_tr_b16 v[88:89], v137 offset:16384
    ds_read_b64_tr_b16 v[90:91], v137 offset:17408
    ds_read_b64_tr_b16 v[92:93], v138 offset:16384
    ds_read_b64_tr_b16 v[94:95], v138 offset:17408
    s_and_b32 s5, s3, 6
    s_add_u32 s4, s4, s5
    s_add_u32 s4, s4, 129024
    v_cmp_gt_u32 vcc, 32, v1
    v_mfma_f32_32x32x16_bf16 v[48:63], v[68:71], v[72:75], v[48:63]
    buffer_load_dwordx4 v[176:179], v11, s[80:83], s56 offen offset:0
    v_add_u32 v3, s4, v3
    s_nop 0
    v_cndmask_b32 v2, v3, v2, vcc
    v_lshlrev_b32 v12, 7, v2
    s_and_b32 s4, s3, 3
    s_lshl_b32 s4, s4, 2
    s_lshr_b32 s38, 0x4620, s4
    v_mfma_f32_32x32x16_bf16 v[32:47], v[76:79], v[84:87], v[32:47]
    ds_read_b128 v[72:75], v130 offset:0
    ds_read_b64_tr_b16 v[64:65], v137 offset:20480
    ds_read_b64_tr_b16 v[66:67], v137 offset:21504
    ds_read_b64_tr_b16 v[68:69], v138 offset:20480
    ds_read_b64_tr_b16 v[70:71], v138 offset:21504
    s_and_b32 s38, s38, 15
    s_lshl_b32 s38, s38, 9
    s_lshr_b32 s7, s3, 2
    s_mul_i32 s6, s7, 33344
    v_mfma_f32_32x32x16_bf16 v[48:63], v[80:83], v[84:87], v[48:63]
    buffer_load_dwordx4 v[180:183], v11, s[80:83], s56 offen offset:896
    s_add_u32 s6, s6, 98232
    s_sub_u32 s6, s6, s38
    v_and_b32 v5, 15, v1
    v_lshrrev_b32 v4, 4, v1
    v_lshlrev_b32 v5, 5, v5
    v_lshl_add_u32 v2, v4, 3, v5
    v_sub_u32 v16, s6, v2
    s_waitcnt lgkmcnt(5)
    v_mfma_f32_32x32x16_bf16 v[32:47], v[88:91], v[96:99], v[32:47]
    ds_read_b128 v[84:87], v131 offset:0
    ds_read_b64_tr_b16 v[76:77], v137 offset:24576
    ds_read_b64_tr_b16 v[78:79], v137 offset:25600
    ds_read_b64_tr_b16 v[80:81], v138 offset:24576
    ds_read_b64_tr_b16 v[82:83], v138 offset:25600
    v_lshrrev_b32 v2, 5, v1
    v_lshl_add_u32 v5, v2, 4, v5
    v_and_b32 v4, 1, v4
    v_lshl_add_u32 v18, v4, 9, v5
    v_mfma_f32_32x32x16_bf16 v[48:63], v[92:95], v[96:99], v[48:63]
    buffer_load_dwordx2 v[116:117], v113, s[72:75], 0 offen sc1
    buffer_load_dwordx4 v[184:187], v11, s[80:83], s56 offen offset:1792
    s_lshl_b32 s6, s2, 1
    s_add_u32 s6, s6, s7
    s_lshl_b32 s6, s6, 12
    s_add_u32 s6, s6, s38
    s_add_u32 s33, s6, 10485760
    s_lshl_b32 s6, s100, 16
    s_waitcnt lgkmcnt(5)
    v_mfma_f32_32x32x16_bf16 v[32:47], v[64:67], v[72:75], v[32:47]
    ds_read_b128 v[96:99], v132 offset:0
    ds_read_b64_tr_b16 v[88:89], v137 offset:28672
    ds_read_b64_tr_b16 v[90:91], v137 offset:29696
    ds_read_b64_tr_b16 v[92:93], v138 offset:28672
    ds_read_b64_tr_b16 v[94:95], v138 offset:29696
    s_and_b32 s8, s100, 0xffff0000
    s_cmp_eq_u32 s7, 0
    s_cselect_b32 s35, s6, s8
    s_mov_b32 s36, 0
    v_mfma_f32_32x32x16_bf16 v[48:63], v[68:71], v[72:75], v[48:63]
    buffer_load_dwordx4 v[188:191], v11, s[80:83], s56 offen offset:2688
    s_lshr_b32 s4, s14, 3
    s_lshl_b32 s4, s4, 2
    s_lshr_b32 s5, 0x2310, s4
    s_and_b32 s5, s5, 3
    s_lshl_b32 s4, s15, 3
    s_add_u32 s4, s4, s3
    s_lshl_b32 s6, s4, 15
    s_waitcnt lgkmcnt(5)
    v_mfma_f32_32x32x16_bf16 v[32:47], v[76:79], v[84:87], v[32:47]
    s_waitcnt lgkmcnt(0)
    s_waitcnt vmcnt(11)
    s_barrier
    ds_read_b128 v[72:75], v129 offset:32768
    ds_read_b64_tr_b16 v[64:65], v137 offset:49152
    ds_read_b64_tr_b16 v[66:67], v137 offset:50176
    ds_read_b64_tr_b16 v[68:69], v138 offset:49152
    ds_read_b64_tr_b16 v[70:71], v138 offset:50176
    s_lshl_b32 s4, s4, 5
    s_add_u32 s4, s4, s5
    s_lshl_b32 s4, s4, 7
    s_add_u32 s4, s4, 16252928
    v_mfma_f32_32x32x16_bf16 v[48:63], v[80:83], v[84:87], v[48:63]
    buffer_load_dwordx4 v[192:195], v11, s[80:83], s57 offen offset:0
    v_lshrrev_b32 v2, 3, v1
    v_lshl_add_u32 v19, v2, 9, s4
    v_and_b32 v3, 7, v1
    v_lshlrev_b32 v4, 12, v2
    v_lshl_add_u32 v20, v3, 4, v4
    s_lshl_b32 s5, s14, 7
    s_add_u32 s6, s6, s5
    v_mfma_f32_32x32x16_bf16 v[32:47], v[88:91], v[96:99], v[32:47]
    ds_read_b128 v[84:87], v130 offset:32768
    ds_read_b64_tr_b16 v[76:77], v137 offset:53248
    ds_read_b64_tr_b16 v[78:79], v137 offset:54272
    ds_read_b64_tr_b16 v[80:81], v138 offset:53248
    ds_read_b64_tr_b16 v[82:83], v138 offset:54272
    s_add_u32 s34, s6, 10485760
    v_xor_b32 v3, s3, v3
    v_lshlrev_b32 v3, 4, v3
    v_lshl_add_u32 v3, v2, 7, v3
    v_mfma_f32_32x32x16_bf16 v[48:63], v[92:95], v[96:99], v[48:63]
    buffer_load_dwordx4 v[196:199], v11, s[80:83], s57 offen offset:896
    s_lshl_b32 s5, s3, 11
    s_add_u32 s5, s5, 147456
    v_add_u32 v21, s5, v3
    s_lshr_b32 s4, s3, 1
    s_lshl_b32 s4, s4, 4
    s_and_b32 s5, s3, 1
    s_lshl_b32 s5, s5, 1
    s_waitcnt lgkmcnt(5)
    v_mfma_f32_32x32x16_bf16 v[32:47], v[64:67], v[72:75], v[32:47]
    ds_read_b128 v[96:99], v131 offset:32768
    ds_read_b64_tr_b16 v[88:89], v137 offset:57344
    ds_read_b64_tr_b16 v[90:91], v137 offset:58368
    ds_read_b64_tr_b16 v[92:93], v138 offset:57344
    ds_read_b64_tr_b16 v[94:95], v138 offset:58368
    s_add_u32 s4, s4, s5
    s_lshl_b32 s5, s14, 6
    v_bfe_u32 v2, v1, 3, 2
    v_lshrrev_b32 v3, 5, v1
    v_mfma_f32_32x32x16_bf16 v[48:63], v[68:71], v[72:75], v[48:63]
    buffer_load_dwordx4 v[200:203], v11, s[80:83], s57 offen offset:1792
    v_lshl_add_u32 v2, v2, 2, v3
    v_add_u32 v6, s4, v2
    v_add_u32 v4, s5, v6
    v_mul_u32_u24 v2, 896, v4
    v_bfe_u32 v3, v1, 1, 2
    v_lshl_add_u32 v2, v3, 5, v2
    v_and_b32 v5, 1, v1
    s_waitcnt lgkmcnt(5)
    v_mfma_f32_32x32x16_bf16 v[32:47], v[76:79], v[84:87], v[32:47]
    ds_read_b128 v[72:75], v132 offset:32768
    ds_read_b64_tr_b16 v[64:65], v137 offset:61440
    ds_read_b64_tr_b16 v[66:67], v137 offset:62464
    ds_read_b64_tr_b16 v[68:69], v138 offset:61440
    ds_read_b64_tr_b16 v[70:71], v138 offset:62464
    v_lshl_add_u32 v2, v5, 3, v2
    s_lshl_b32 s4, s15, 7
    v_add_u32 v22, s4, v2
    v_lshlrev_b32 v4, 2, v4
    v_mfma_f32_32x32x16_bf16 v[48:63], v[80:83], v[84:87], v[48:63]
    buffer_load_dwordx4 v[204:207], v11, s[80:83], s57 offen offset:2688
    v_add_u32 v24, 12582912, v4
    v_lshlrev_b32 v2, 1, v3
    v_lshrrev_b32 v3, 3, v6
    v_xor_b32 v3, v3, v2
    v_lshlrev_b32 v4, 11, v2
    v_lshl_add_u32 v4, v5, 9, v4
    v_and_b32 v6, 7, v6
    s_waitcnt lgkmcnt(5)
    v_mfma_f32_32x32x16_bf16 v[32:47], v[88:91], v[96:99], v[32:47]
    v_lshl_add_u32 v4, v6, 1, v4
    v_add_u32 v4, 147456, v4
    v_lshl_add_u32 v25, v3, 4, v4
    s_lshr_b32 s4, s3, 2
    s_lshl_b32 s4, s4, 16
    s_and_b32 s5, s3, 3
    s_lshl_b32 s5, s5, 11
    s_add_u32 s4, s4, s5
    v_lshrrev_b32 v3, 5, v1
    v_mfma_f32_32x32x16_bf16 v[48:63], v[92:95], v[96:99], v[48:63]
    s_waitcnt vmcnt(6)
    v_cmp_ne_u64 s[40:41], s[96:97], v[116:117]
    s_cmp_lg_u64 s[40:41], 0
    s_cbranch_scc0 L_pok_5
L_pre_6:
    s_cmp_eq_u32 s19, 0
    s_cbranch_scc1 L_pok_5
    s_sub_u32 s19, s19, 1
    s_sleep 2
    buffer_load_dwordx2 v[116:117], v113, s[72:75], 0 offen sc1
    s_waitcnt vmcnt(0)
    v_cmp_ne_u64 s[40:41], s[96:97], v[116:117]
    s_cmp_lg_u64 s[40:41], 0
    s_cbranch_scc1 L_pre_6
L_pok_5:
    buffer_load_dwordx4 v[100:103], v114, s[72:75], s26 offen sc1
    buffer_load_dwordx4 v[104:107], v115, s[72:75], s26 offen sc1
    buffer_load_dwordx4 v[208:211], v11, s[80:83], s58 offen offset:0
    s_waitcnt lgkmcnt(0)
    v_mfma_f32_32x32x16_bf16 v[32:47], v[64:67], v[72:75], v[32:47]
    v_lshlrev_b32 v3, 10, v3
    v_bfe_u32 v4, v1, 3, 2
    v_lshl_add_u32 v3, v4, 6, v3
    v_lshl_add_u32 v3, v2, 2, v3
    v_lshl_add_u32 v3, v5, 5, v3
    v_add_u32 v26, s4, v3
    v_lshrrev_b32 v2, 5, v1
    v_bfe_u32 v3, v1, 4, 1
    v_lshlrev_b32 v2, 10, v2
    v_mfma_f32_32x32x16_bf16 v[48:63], v[68:71], v[72:75], v[48:63]
    buffer_load_dwordx4 v[212:215], v11, s[80:83], s58 offen offset:896
    v_lshl_add_u32 v2, v3, 9, v2
    v_and_b32 v3, 15, v1
    v_lshl_add_u32 v13, v3, 4, v2
    v_add_u32 v29, 114688, v13
    s_mul_i32 s5, s14, 224
    s_mul_i32 s4, s3, 14
    s_add_u32 s5, s5, s4
    s_lshl_b32 s5, s5, 10
    s_lshl_b32 s31, s3, 13
    s_lshl_b32 s32, s3, 11
    s_add_u32 s32, s32, 131072
    v_add_u32 v27, s31, v10
    v_add_u32 v14, s32, v10
    v_xor_b32 v2, 0x1000, v14
    v_add_u32 v15, 16384, v2
    s_bfe_u32 s4, s37, 262144
    s_lshl_b32 s4, s4, 11
    s_add_u32 s48, s4, s5
    s_bfe_u32 s4, s37, 262148
    s_lshl_b32 s4, s4, 11
    s_add_u32 s49, s4, s5
    s_bfe_u32 s4, s37, 262152
    s_lshl_b32 s4, s4, 11
    s_add_u32 s50, s4, s5
    s_bfe_u32 s4, s37, 262156
    s_lshl_b32 s4, s4, 11
    s_add_u32 s51, s4, s5
    s_bfe_u32 s4, s37, 262160
    s_lshl_b32 s4, s4, 11
    s_add_u32 s52, s4, s5
    s_bfe_u32 s4, s37, 262164
    s_lshl_b32 s4, s4, 11
    s_add_u32 s53, s4, s5
    s_bfe_u32 s4, s37, 262168
    s_lshl_b32 s4, s4, 11
    s_add_u32 s54, s4, s5
    v_mov_b32 v4, 0
    v_mov_b32 v5, 0
    v_mov_b32 v6, 0
    v_mov_b32 v7, 0
    s_mov_b64 exec, 3
    ds_write_b128 v143, v[4:7]
    s_mov_b64 exec, -1
    s_nop 7
    s_nop 7
    v_pk_mul_f32 v[80:81], v[32:33], s[18:19] op_sel_hi:[1,0]
    v_pk_mul_f32 v[82:83], v[34:35], s[18:19] op_sel_hi:[1,0]
    v_exp_f32 v80, v80
    v_exp_f32 v81, v81
    v_exp_f32 v82, v82
    v_exp_f32 v83, v83
    v_pk_fma_f32 v[84:85], v[80:81], 0.5, 1.0 op_sel_hi:[1,0,0]
    v_pk_fma_f32 v[86:87], v[82:83], 0.5, 1.0 op_sel_hi:[1,0,0]
    v_pk_fma_f32 v[80:81], v[80:81], v[84:85], 1.0 op_sel_hi:[1,1,0]
    v_pk_fma_f32 v[82:83], v[82:83], v[86:87], 1.0 op_sel_hi:[1,1,0]
    v_rcp_f32 v80, v80
    v_rcp_f32 v81, v81
    v_rcp_f32 v82, v82
    v_rcp_f32 v83, v83
    v_pk_fma_f32 v[32:33], v[32:33], v[80:81], v[32:33] neg_lo:[1,0,0] neg_hi:[1,0,0]
    v_pk_fma_f32 v[34:35], v[34:35], v[82:83], v[34:35] neg_lo:[1,0,0] neg_hi:[1,0,0]
    v_pk_mul_f32 v[80:81], v[36:37], s[18:19] op_sel_hi:[1,0]
    v_pk_mul_f32 v[82:83], v[38:39], s[18:19] op_sel_hi:[1,0]
    v_exp_f32 v80, v80
    v_exp_f32 v81, v81
    v_exp_f32 v82, v82
    v_exp_f32 v83, v83
    v_pk_fma_f32 v[84:85], v[80:81], 0.5, 1.0 op_sel_hi:[1,0,0]
    v_pk_fma_f32 v[86:87], v[82:83], 0.5, 1.0 op_sel_hi:[1,0,0]
    v_pk_fma_f32 v[80:81], v[80:81], v[84:85], 1.0 op_sel_hi:[1,1,0]
    v_pk_fma_f32 v[82:83], v[82:83], v[86:87], 1.0 op_sel_hi:[1,1,0]
    v_rcp_f32 v80, v80
    v_rcp_f32 v81, v81
    v_rcp_f32 v82, v82
    v_rcp_f32 v83, v83
    v_pk_fma_f32 v[36:37], v[36:37], v[80:81], v[36:37] neg_lo:[1,0,0] neg_hi:[1,0,0]
    v_pk_fma_f32 v[38:39], v[38:39], v[82:83], v[38:39] neg_lo:[1,0,0] neg_hi:[1,0,0]
    v_cvt_pk_bf16_f32 v32, v32, v33
    v_cvt_pk_bf16_f32 v33, v34, v35
    v_cvt_pk_bf16_f32 v34, v36, v37
    v_cvt_pk_bf16_f32 v35, v38, v39
    buffer_store_dwordx4 v[32:35], v10, s[72:75], s30 offen offset:0 sc1
    v_pk_mul_f32 v[80:81], v[40:41], s[18:19] op_sel_hi:[1,0]
    v_pk_mul_f32 v[82:83], v[42:43], s[18:19] op_sel_hi:[1,0]
    v_exp_f32 v80, v80
    v_exp_f32 v81, v81
    v_exp_f32 v82, v82
    v_exp_f32 v83, v83
    v_pk_fma_f32 v[84:85], v[80:81], 0.5, 1.0 op_sel_hi:[1,0,0]
    v_pk_fma_f32 v[86:87], v[82:83], 0.5, 1.0 op_sel_hi:[1,0,0]
    v_pk_fma_f32 v[80:81], v[80:81], v[84:85], 1.0 op_sel_hi:[1,1,0]
    v_pk_fma_f32 v[82:83], v[82:83], v[86:87], 1.0 op_sel_hi:[1,1,0]
    v_rcp_f32 v80, v80
    v_rcp_f32 v81, v81
    v_rcp_f32 v82, v82
    v_rcp_f32 v83, v83
    v_pk_fma_f32 v[40:41], v[40:41], v[80:81], v[40:41] neg_lo:[1,0,0] neg_hi:[1,0,0]
    v_pk_fma_f32 v[42:43], v[42:43], v[82:83], v[42:43] neg_lo:[1,0,0] neg_hi:[1,0,0]
    v_pk_mul_f32 v[80:81], v[44:45], s[18:19] op_sel_hi:[1,0]
    v_pk_mul_f32 v[82:83], v[46:47], s[18:19] op_sel_hi:[1,0]
    v_exp_f32 v80, v80
    v_exp_f32 v81, v81
    v_exp_f32 v82, v82
    v_exp_f32 v83, v83
    v_pk_fma_f32 v[84:85], v[80:81], 0.5, 1.0 op_sel_hi:[1,0,0]
    v_pk_fma_f32 v[86:87], v[82:83], 0.5, 1.0 op_sel_hi:[1,0,0]
    v_pk_fma_f32 v[80:81], v[80:81], v[84:85], 1.0 op_sel_hi:[1,1,0]
    v_pk_fma_f32 v[82:83], v[82:83], v[86:87], 1.0 op_sel_hi:[1,1,0]
    v_rcp_f32 v80, v80
    v_rcp_f32 v81, v81
    v_rcp_f32 v82, v82
    v_rcp_f32 v83, v83
    v_pk_fma_f32 v[44:45], v[44:45], v[80:81], v[44:45] neg_lo:[1,0,0] neg_hi:[1,0,0]
    v_pk_fma_f32 v[46:47], v[46:47], v[82:83], v[46:47] neg_lo:[1,0,0] neg_hi:[1,0,0]
    v_cvt_pk_bf16_f32 v40, v40, v41
    v_cvt_pk_bf16_f32 v41, v42, v43
    v_cvt_pk_bf16_f32 v42, v44, v45
    v_cvt_pk_bf16_f32 v43, v46, v47
    buffer_store_dwordx4 v[40:43], v10, s[72:75], s30 offen offset:1024 sc1
    v_pk_mul_f32 v[80:81], v[48:49], s[18:19] op_sel_hi:[1,0]
    v_pk_mul_f32 v[82:83], v[50:51], s[18:19] op_sel_hi:[1,0]
    v_exp_f32 v80, v80
    v_exp_f32 v81, v81
    v_exp_f32 v82, v82
    v_exp_f32 v83, v83
    v_pk_fma_f32 v[84:85], v[80:81], 0.5, 1.0 op_sel_hi:[1,0,0]
    v_pk_fma_f32 v[86:87], v[82:83], 0.5, 1.0 op_sel_hi:[1,0,0]
    v_pk_fma_f32 v[80:81], v[80:81], v[84:85], 1.0 op_sel_hi:[1,1,0]
    v_pk_fma_f32 v[82:83], v[82:83], v[86:87], 1.0 op_sel_hi:[1,1,0]
    v_rcp_f32 v80, v80
    v_rcp_f32 v81, v81
    v_rcp_f32 v82, v82
    v_rcp_f32 v83, v83
    v_pk_fma_f32 v[48:49], v[48:49], v[80:81], v[48:49] neg_lo:[1,0,0] neg_hi:[1,0,0]
    v_pk_fma_f32 v[50:51], v[50:51], v[82:83], v[50:51] neg_lo:[1,0,0] neg_hi:[1,0,0]
    v_pk_mul_f32 v[80:81], v[52:53], s[18:19] op_sel_hi:[1,0]
    v_pk_mul_f32 v[82:83], v[54:55], s[18:19] op_sel_hi:[1,0]
    v_exp_f32 v80, v80
    v_exp_f32 v81, v81
    v_exp_f32 v82, v82
    v_exp_f32 v83, v83
    v_pk_fma_f32 v[84:85], v[80:81], 0.5, 1.0 op_sel_hi:[1,0,0]
    v_pk_fma_f32 v[86:87], v[82:83], 0.5, 1.0 op_sel_hi:[1,0,0]
    v_pk_fma_f32 v[80:81], v[80:81], v[84:85], 1.0 op_sel_hi:[1,1,0]
    v_pk_fma_f32 v[82:83], v[82:83], v[86:87], 1.0 op_sel_hi:[1,1,0]
    v_rcp_f32 v80, v80
    v_rcp_f32 v81, v81
    v_rcp_f32 v82, v82
    v_rcp_f32 v83, v83
    v_pk_fma_f32 v[52:53], v[52:53], v[80:81], v[52:53] neg_lo:[1,0,0] neg_hi:[1,0,0]
    v_pk_fma_f32 v[54:55], v[54:55], v[82:83], v[54:55] neg_lo:[1,0,0] neg_hi:[1,0,0]
    v_cvt_pk_bf16_f32 v48, v48, v49
    v_cvt_pk_bf16_f32 v49, v50, v51
    v_cvt_pk_bf16_f32 v50, v52, v53
    v_cvt_pk_bf16_f32 v51, v54, v55
    buffer_store_dwordx4 v[48:51], v10, s[72:75], s30 offen offset:2048 sc1
    v_pk_mul_f32 v[80:81], v[56:57], s[18:19] op_sel_hi:[1,0]
    v_pk_mul_f32 v[82:83], v[58:59], s[18:19] op_sel_hi:[1,0]
    v_exp_f32 v80, v80
    v_exp_f32 v81, v81
    v_exp_f32 v82, v82
    v_exp_f32 v83, v83
    v_pk_fma_f32 v[84:85], v[80:81], 0.5, 1.0 op_sel_hi:[1,0,0]
    v_pk_fma_f32 v[86:87], v[82:83], 0.5, 1.0 op_sel_hi:[1,0,0]
    v_pk_fma_f32 v[80:81], v[80:81], v[84:85], 1.0 op_sel_hi:[1,1,0]
    v_pk_fma_f32 v[82:83], v[82:83], v[86:87], 1.0 op_sel_hi:[1,1,0]
    v_rcp_f32 v80, v80
    v_rcp_f32 v81, v81
    v_rcp_f32 v82, v82
    v_rcp_f32 v83, v83
    v_pk_fma_f32 v[56:57], v[56:57], v[80:81], v[56:57] neg_lo:[1,0,0] neg_hi:[1,0,0]
    v_pk_fma_f32 v[58:59], v[58:59], v[82:83], v[58:59] neg_lo:[1,0,0] neg_hi:[1,0,0]
    v_pk_mul_f32 v[80:81], v[60:61], s[18:19] op_sel_hi:[1,0]
    v_pk_mul_f32 v[82:83], v[62:63], s[18:19] op_sel_hi:[1,0]
    v_exp_f32 v80, v80
    v_exp_f32 v81, v81
    v_exp_f32 v82, v82
    v_exp_f32 v83, v83
    v_pk_fma_f32 v[84:85], v[80:81], 0.5, 1.0 op_sel_hi:[1,0,0]
    v_pk_fma_f32 v[86:87], v[82:83], 0.5, 1.0 op_sel_hi:[1,0,0]
    v_pk_fma_f32 v[80:81], v[80:81], v[84:85], 1.0 op_sel_hi:[1,1,0]
    v_pk_fma_f32 v[82:83], v[82:83], v[86:87], 1.0 op_sel_hi:[1,1,0]
    v_rcp_f32 v80, v80
    v_rcp_f32 v81, v81
    v_rcp_f32 v82, v82
    v_rcp_f32 v83, v83
    v_pk_fma_f32 v[60:61], v[60:61], v[80:81], v[60:61] neg_lo:[1,0,0] neg_hi:[1,0,0]
    v_pk_fma_f32 v[62:63], v[62:63], v[82:83], v[62:63] neg_lo:[1,0,0] neg_hi:[1,0,0]
    v_cvt_pk_bf16_f32 v56, v56, v57
    v_cvt_pk_bf16_f32 v57, v58, v59
    v_cvt_pk_bf16_f32 v58, v60, v61
    v_cvt_pk_bf16_f32 v59, v62, v63
    buffer_store_dwordx4 v[56:59], v10, s[72:75], s30 offen offset:3072 sc1
    s_waitcnt vmcnt(6)
    ds_write_b128 v142, v[100:103] offset:29120
    ds_write_b128 v142, v[102:105] offset:12480
    v_mov_b32 v108, v101
    v_mov_b32 v109, v102
    v_mov_b32 v110, v103
    v_mov_b32 v111, v104
    v_mov_b32 v112, v105
    v_mov_b32 v113, v106
    ds_write_b128 v142, v[108:111] offset:20800
    ds_write_b128 v142, v[110:113] offset:4160
    v_alignbyte_b32 v114, v101, v100, 2
    v_alignbyte_b32 v115, v102, v101, 2
    v_alignbyte_b32 v116, v103, v102, 2
    v_alignbyte_b32 v117, v104, v103, 2
    v_alignbyte_b32 v118, v105, v104, 2
    v_alignbyte_b32 v119, v106, v105, 2
    ds_write_b128 v142, v[114:117] offset:24960
    ds_write_b128 v142, v[116:119] offset:8320
    v_alignbyte_b32 v120, v102, v101, 2
    v_alignbyte_b32 v121, v103, v102, 2
    v_alignbyte_b32 v122, v104, v103, 2
    v_alignbyte_b32 v123, v105, v104, 2
    v_alignbyte_b32 v124, v106, v105, 2
    v_alignbyte_b32 v125, v107, v106, 2
    ds_write_b128 v142, v[120:123] offset:16640
    ds_write_b128 v142, v[122:125] offset:0
    s_cmp_ge_u32 s3, 4
    s_cbranch_scc0 L_pr_7
    s_setprio 1
L_pr_7:
    s_waitcnt lgkmcnt(0)
    s_cmp_ge_u32 s3, 4
    s_cbranch_scc1 L_afs_8
    s_waitcnt vmcnt(0)
    buffer_store_dwordx2 v[30:31], v28, s[72:75], s24 offen sc1
L_afs_8:
    s_barrier
    s_bitcmp1_b32 s3, 0
    s_cbranch_scc1 L_cv_rs1_9
    ds_read_b128 v[100:103], v8 offset:3776
    ds_read_b128 v[104:107], v9 offset:192
    ds_read_b128 v[108:111], v9 offset:704
    ds_read_b128 v[112:115], v9 offset:3264
    ds_read_b128 v[116:119], v9 offset:3776
    ds_read_b128 v[120:123], v8 offset:3264
    ds_read_b128 v[80:83], v9 offset:2752
    ds_read_b128 v[84:87], v8 offset:2752
    ds_read_b128 v[88:91], v9 offset:2240
    ds_read_b128 v[92:95], v8 offset:2240
    ds_read_b128 v[96:99], v9 offset:1728
    s_waitcnt lgkmcnt(10)
    s_waitcnt lgkmcnt(9)
    v_mfma_f32_16x16x32_bf16 v[124:127], v[100:103], v[104:107], 0
    buffer_load_dwordx4 v[216:219], v11, s[80:83], s58 offen offset:1792
    s_mov_b64 vcc, s[20:21]
    v_cndmask_b32_dpp v17, v162, v160, vcc row_ror:8 row_mask:0xf bank_mask:0xf
    s_waitcnt lgkmcnt(8)
    v_mfma_f32_16x16x32_bf16 v[128:131], v[100:103], v[108:111], 0
    v_mov_b32_dpp v162, v160 row_ror:8 row_mask:0xf bank_mask:0x3
    v_cndmask_b32_dpp v160, v163, v161, vcc row_ror:8 row_mask:0xf bank_mask:0xf
    v_mov_b32_dpp v163, v161 row_ror:8 row_mask:0xf bank_mask:0x3
    s_waitcnt lgkmcnt(7)
    v_mfma_f32_16x16x32_bf16 v[132:135], v[100:103], v[112:115], 0
    buffer_load_dwordx4 v[220:223], v11, s[80:83], s58 offen offset:2688
    v_cndmask_b32_dpp v161, v166, v164, vcc row_ror:8 row_mask:0xf bank_mask:0xf
    v_mov_b32_dpp v166, v164 row_ror:8 row_mask:0xf bank_mask:0x3
    s_waitcnt lgkmcnt(6)
    v_mfma_f32_16x16x32_bf16 v[136:139], v[100:103], v[116:119], 0
    ds_read_b128 v[100:103], v8 offset:1728
    ds_read_b128 v[116:119], v9 offset:1216
    v_cndmask_b32_dpp v164, v167, v165, vcc row_ror:8 row_mask:0xf bank_mask:0xf
    v_mov_b32_dpp v167, v165 row_ror:8 row_mask:0xf bank_mask:0x3
    v_cndmask_b32_dpp v165, v170, v168, vcc row_ror:8 row_mask:0xf bank_mask:0xf
    s_waitcnt lgkmcnt(7)
    v_mfma_f32_16x16x32_bf16 v[128:131], v[120:123], v[104:107], v[128:131]
    s_cmp_ge_u32 s3, 4
    s_cbranch_scc0 L_afs_11
    s_waitcnt vmcnt(2)
    buffer_store_dwordx2 v[30:31], v28, s[72:75], s24 offen sc1
L_afs_11:
    buffer_load_dwordx4 v[224:227], v11, s[80:83], s59 offen offset:0
    s_waitcnt lgkmcnt(6)
    v_mfma_f32_16x16x32_bf16 v[132:135], v[120:123], v[80:83], v[132:135]
    v_mfma_f32_16x16x32_bf16 v[136:139], v[120:123], v[112:115], v[136:139]
    ds_read_b128 v[120:123], v8 offset:1216
    ds_read_b128 v[112:115], v8 offset:704
    buffer_load_dwordx4 v[228:231], v11, s[80:83], s59 offen offset:896
    v_mov_b32_dpp v170, v168 row_ror:8 row_mask:0xf bank_mask:0x3
    v_cndmask_b32_dpp v168, v171, v169, vcc row_ror:8 row_mask:0xf bank_mask:0xf
    s_waitcnt lgkmcnt(7)
    s_waitcnt lgkmcnt(6)
    v_mfma_f32_16x16x32_bf16 v[132:135], v[84:87], v[88:91], v[132:135]
    v_mov_b32_dpp v171, v169 row_ror:8 row_mask:0xf bank_mask:0x3
    v_cndmask_b32_dpp v169, v174, v172, vcc row_ror:8 row_mask:0xf bank_mask:0xf
    v_mov_b32_dpp v174, v172 row_ror:8 row_mask:0xf bank_mask:0x3
    v_mfma_f32_16x16x32_bf16 v[136:139], v[84:87], v[80:83], v[136:139]
    ds_read_b128 v[84:87], v8 offset:192
    ds_read_b128 v[80:83], v8 offset:128
    buffer_load_dwordx4 v[232:235], v11, s[80:83], s59 offen offset:1792
    v_cndmask_b32_dpp v172, v175, v173, vcc row_ror:8 row_mask:0xf bank_mask:0xf
    v_mov_b32_dpp v175, v173 row_ror:8 row_mask:0xf bank_mask:0x3
    s_waitcnt lgkmcnt(7)
    s_waitcnt lgkmcnt(6)
    v_mfma_f32_16x16x32_bf16 v[132:135], v[92:95], v[96:99], v[132:135]
    v_perm_b32 v144, v161, v17, s16
    v_perm_b32 v148, v161, v17, s17
    v_perm_b32 v152, v164, v160, s16
    v_mfma_f32_16x16x32_bf16 v[136:139], v[92:95], v[88:91], v[136:139]
    ds_read_b128 v[92:95], v9 offset:128
    ds_read_b128 v[88:91], v8 offset:640
    buffer_load_dwordx4 v[236:239], v11, s[80:83], s59 offen offset:2688
    v_perm_b32 v156, v164, v160, s17
    v_perm_b32 v145, v169, v165, s16
    s_waitcnt lgkmcnt(7)
    s_waitcnt lgkmcnt(6)
    v_mfma_f32_16x16x32_bf16 v[132:135], v[100:103], v[116:119], v[132:135]
    v_perm_b32 v149, v169, v165, s17
    v_perm_b32 v153, v172, v168, s16
    v_perm_b32 v157, v172, v168, s17
    v_mfma_f32_16x16x32_bf16 v[136:139], v[100:103], v[96:99], v[136:139]
    ds_read_b128 v[100:103], v9 offset:640
    ds_read_b128 v[96:99], v8 offset:1152
    buffer_load_dwordx4 v[240:243], v11, s[80:83], s64 offen offset:0
    v_perm_b32 v146, v166, v162, s16
    v_perm_b32 v150, v166, v162, s17
    s_waitcnt lgkmcnt(7)
    v_mfma_f32_16x16x32_bf16 v[132:135], v[120:123], v[108:111], v[132:135]
    v_perm_b32 v154, v167, v163, s16
    v_perm_b32 v158, v167, v163, s17
    v_perm_b32 v147, v174, v170, s16
    v_mfma_f32_16x16x32_bf16 v[136:139], v[120:123], v[116:119], v[136:139]
    ds_read_b128 v[120:123], v9 offset:1152
    ds_read_b128 v[116:119], v8 offset:1664
    buffer_load_dwordx4 v[244:247], v11, s[80:83], s64 offen offset:896
    v_perm_b32 v151, v174, v170, s17
    v_perm_b32 v155, v175, v171, s16
    s_waitcnt lgkmcnt(8)
    v_mfma_f32_16x16x32_bf16 v[132:135], v[112:115], v[104:107], v[132:135]
    v_perm_b32 v159, v175, v171, s17
    s_mov_b64 vcc, s[20:21]
    v_cndmask_b32_dpp v17, v178, v176, vcc row_ror:8 row_mask:0xf bank_mask:0xf
    v_mfma_f32_16x16x32_bf16 v[136:139], v[112:115], v[108:111], v[136:139]
    ds_read_b128 v[112:115], v9 offset:1664
    ds_read_b128 v[108:111], v8 offset:2176
    buffer_load_dwordx4 v[248:251], v11, s[80:83], s64 offen offset:1792
    v_mov_b32_dpp v178, v176 row_ror:8 row_mask:0xf bank_mask:0x3
    v_cndmask_b32_dpp v176, v179, v177, vcc row_ror:8 row_mask:0xf bank_mask:0xf
    s_waitcnt lgkmcnt(9)
    v_mfma_f32_16x16x32_bf16 v[136:139], v[84:87], v[104:107], v[136:139]
    ds_read_b128 v[84:87], v9 offset:2176
    ds_read_b128 v[104:107], v8 offset:2688
    v_mov_b32_dpp v179, v177 row_ror:8 row_mask:0xf bank_mask:0x3
    v_cndmask_b32_dpp v177, v182, v180, vcc row_ror:8 row_mask:0xf bank_mask:0xf
    v_mov_b32_dpp v182, v180 row_ror:8 row_mask:0xf bank_mask:0x3
    s_waitcnt lgkmcnt(10)
    s_waitcnt lgkmcnt(9)
    v_mfma_f32_16x16x32_bf16 v[136:139], v[80:83], v[92:95], v[136:139]
    ds_read_b128 v[80:83], v9 offset:2688
    buffer_load_dwordx4 v[252:255], v11, s[80:83], s64 offen offset:2688
    v_cndmask_b32_dpp v180, v183, v181, vcc row_ror:8 row_mask:0xf bank_mask:0xf
    v_mov_b32_dpp v183, v181 row_ror:8 row_mask:0xf bank_mask:0x3
    s_waitcnt lgkmcnt(9)
    v_mfma_f32_16x16x32_bf16 v[132:135], v[88:91], v[92:95], v[132:135]
    v_cndmask_b32_dpp v181, v186, v184, vcc row_ror:8 row_mask:0xf bank_mask:0xf
    v_mov_b32_dpp v186, v184 row_ror:8 row_mask:0xf bank_mask:0x3
    v_cndmask_b32_dpp v184, v187, v185, vcc row_ror:8 row_mask:0xf bank_mask:0xf
    s_waitcnt lgkmcnt(8)
    v_mfma_f32_16x16x32_bf16 v[136:139], v[88:91], v[100:103], v[136:139]
    ds_read_b128 v[88:91], v8 offset:3200
    buffer_load_dwordx4 v[64:67], v11, s[80:83], s65 offen offset:0
    v_mov_b32_dpp v187, v185 row_ror:8 row_mask:0xf bank_mask:0x3
    v_cndmask_b32_dpp v185, v190, v188, vcc row_ror:8 row_mask:0xf bank_mask:0xf
    s_waitcnt lgkmcnt(8)
    v_mfma_f32_16x16x32_bf16 v[132:135], v[96:99], v[100:103], v[132:135]
    v_mov_b32_dpp v190, v188 row_ror:8 row_mask:0xf bank_mask:0x3
    v_cndmask_b32_dpp v188, v191, v189, vcc row_ror:8 row_mask:0xf bank_mask:0xf
    v_mov_b32_dpp v191, v189 row_ror:8 row_mask:0xf bank_mask:0x3
    s_waitcnt lgkmcnt(7)
    v_mfma_f32_16x16x32_bf16 v[136:139], v[96:99], v[120:123], v[136:139]
    ds_read_b128 v[96:99], v9 offset:3200
    buffer_load_dwordx4 v[68:71], v11, s[80:83], s65 offen offset:896
    v_perm_b32 v160, v177, v17, s16
    v_perm_b32 v164, v177, v17, s17
    s_waitcnt lgkmcnt(7)
    v_mfma_f32_16x16x32_bf16 v[132:135], v[116:119], v[120:123], v[132:135]
    ds_read_b128 v[120:123], v8 offset:3712
    v_perm_b32 v168, v180, v176, s16
    v_perm_b32 v172, v180, v176, s17
    v_perm_b32 v161, v185, v181, s16
    s_waitcnt lgkmcnt(7)
    v_mfma_f32_16x16x32_bf16 v[136:139], v[116:119], v[112:115], v[136:139]
    ds_read_b128 v[116:119], v9 offset:3712
    buffer_load_dwordx4 v[72:75], v11, s[80:83], s65 offen offset:1792
    v_perm_b32 v165, v185, v181, s17
    v_perm_b32 v169, v188, v184, s16
    s_waitcnt lgkmcnt(7)
    v_mfma_f32_16x16x32_bf16 v[132:135], v[108:111], v[112:115], v[132:135]
    ds_read_b128 v[112:115], v8 offset:3648
    v_perm_b32 v173, v188, v184, s17
    v_perm_b32 v162, v182, v178, s16
    v_perm_b32 v166, v182, v178, s17
    s_waitcnt lgkmcnt(7)
    v_mfma_f32_16x16x32_bf16 v[136:139], v[108:111], v[84:87], v[136:139]
    ds_read_b128 v[108:111], v9 offset:64
    buffer_load_dwordx4 v[76:79], v11, s[80:83], s65 offen offset:2688
    v_perm_b32 v170, v183, v179, s16
    v_perm_b32 v174, v183, v179, s17
    s_waitcnt lgkmcnt(7)
    v_mfma_f32_16x16x32_bf16 v[132:135], v[104:107], v[84:87], v[132:135]
    ds_read_b128 v[84:87], v9 offset:576
    v_perm_b32 v163, v190, v186, s16
    v_perm_b32 v167, v190, v186, s17
    v_perm_b32 v171, v191, v187, s16
    s_waitcnt lgkmcnt(7)
    v_mfma_f32_16x16x32_bf16 v[136:139], v[104:107], v[80:83], v[136:139]
    ds_read_b128 v[104:107], v9 offset:3136
    v_perm_b32 v175, v191, v187, s17
    s_mov_b64 vcc, s[20:21]
    v_cndmask_b32_dpp v17, v194, v192, vcc row_ror:8 row_mask:0xf bank_mask:0xf
    s_waitcnt lgkmcnt(7)
    v_mfma_f32_16x16x32_bf16 v[128:131], v[88:91], v[92:95], v[128:131]
    v_mov_b32_dpp v194, v192 row_ror:8 row_mask:0xf bank_mask:0x3
    v_cndmask_b32_dpp v192, v195, v193, vcc row_ror:8 row_mask:0xf bank_mask:0xf
    v_mov_b32_dpp v195, v193 row_ror:8 row_mask:0xf bank_mask:0x3
    v_mfma_f32_16x16x32_bf16 v[132:135], v[88:91], v[80:83], v[132:135]
    ds_read_b128 v[80:83], v9 offset:3648
    v_cndmask_b32_dpp v193, v198, v196, vcc row_ror:8 row_mask:0xf bank_mask:0xf
    v_mov_b32_dpp v198, v196 row_ror:8 row_mask:0xf bank_mask:0x3
    v_cndmask_b32_dpp v196, v199, v197, vcc row_ror:8 row_mask:0xf bank_mask:0xf
    s_waitcnt lgkmcnt(7)
    v_mfma_f32_16x16x32_bf16 v[136:139], v[88:91], v[96:99], v[136:139]
    ds_read_b128 v[88:91], v8 offset:3136
    v_mov_b32_dpp v199, v197 row_ror:8 row_mask:0xf bank_mask:0x3
    v_cndmask_b32_dpp v197, v202, v200, vcc row_ror:8 row_mask:0xf bank_mask:0xf
    v_mov_b32_dpp v202, v200 row_ror:8 row_mask:0xf bank_mask:0x3
    s_waitcnt lgkmcnt(7)
    v_mfma_f32_16x16x32_bf16 v[124:127], v[120:123], v[92:95], v[124:127]
    ds_read_b128 v[92:95], v9 offset:2624
    v_cndmask_b32_dpp v200, v203, v201, vcc row_ror:8 row_mask:0xf bank_mask:0xf
    v_mov_b32_dpp v203, v201 row_ror:8 row_mask:0xf bank_mask:0x3
    v_cndmask_b32_dpp v201, v206, v204, vcc row_ror:8 row_mask:0xf bank_mask:0xf
    v_mfma_f32_16x16x32_bf16 v[128:131], v[120:123], v[100:103], v[128:131]
    ds_read_b128 v[100:103], v8 offset:2624
    v_mov_b32_dpp v206, v204 row_ror:8 row_mask:0xf bank_mask:0x3
    v_cndmask_b32_dpp v204, v207, v205, vcc row_ror:8 row_mask:0xf bank_mask:0xf
    v_mov_b32_dpp v207, v205 row_ror:8 row_mask:0xf bank_mask:0x3
    v_mfma_f32_16x16x32_bf16 v[132:135], v[120:123], v[96:99], v[132:135]
    ds_read_b128 v[96:99], v9 offset:2112
    v_perm_b32 v176, v193, v17, s16
    v_perm_b32 v180, v193, v17, s17
    v_perm_b32 v184, v196, v192, s16
    s_waitcnt lgkmcnt(9)
    v_mfma_f32_16x16x32_bf16 v[136:139], v[120:123], v[116:119], v[136:139]
    ds_read_b128 v[120:123], v8 offset:2112
    ds_read_b128 v[116:119], v9 offset:1600
    v_perm_b32 v188, v196, v192, s17
    v_perm_b32 v177, v201, v197, s16
    v_perm_b32 v181, v201, v197, s17
    s_waitcnt lgkmcnt(10)
    s_waitcnt lgkmcnt(9)
    v_mfma_f32_16x16x32_bf16 v[124:127], v[112:115], v[108:111], v[124:127]
    s_cmp_ge_u32 s3, 4
    s_cbranch_scc0 L_pr_12
    s_setprio 0
L_pr_12:
    s_waitcnt lgkmcnt(8)
    v_mfma_f32_16x16x32_bf16 v[128:131], v[112:115], v[84:87], v[128:131]
    v_perm_b32 v185, v204, v200, s16
    v_perm_b32 v189, v204, v200, s17
    s_waitcnt lgkmcnt(7)
    v_mfma_f32_16x16x32_bf16 v[132:135], v[112:115], v[104:107], v[132:135]
    v_perm_b32 v178, v198, v194, s16
    v_perm_b32 v182, v198, v194, s17
    v_perm_b32 v186, v199, v195, s16
    s_waitcnt lgkmcnt(6)
    v_mfma_f32_16x16x32_bf16 v[136:139], v[112:115], v[80:83], v[136:139]
    ds_read_b128 v[112:115], v8 offset:1600
    ds_read_b128 v[80:83], v9 offset:1088
    v_perm_b32 v190, v199, v195, s17
    v_perm_b32 v179, v206, v202, s16
    v_perm_b32 v183, v206, v202, s17
    s_waitcnt lgkmcnt(7)
    v_mfma_f32_16x16x32_bf16 v[128:131], v[88:91], v[108:111], v[128:131]
    buffer_load_dwordx2 v[6:7], v12, s[72:75], 0 offen sc1
    v_perm_b32 v187, v207, v203, s16
    v_perm_b32 v191, v207, v203, s17
    s_waitcnt lgkmcnt(6)
    v_mfma_f32_16x16x32_bf16 v[132:135], v[88:91], v[92:95], v[132:135]
    s_waitcnt vmcnt(13)
    s_mov_b64 vcc, s[20:21]
    v_cndmask_b32_dpp v17, v210, v208, vcc row_ror:8 row_mask:0xf bank_mask:0xf
    v_mov_b32_dpp v210, v208 row_ror:8 row_mask:0xf bank_mask:0x3
    v_mfma_f32_16x16x32_bf16 v[136:139], v[88:91], v[104:107], v[136:139]
    ds_read_b128 v[88:91], v8 offset:1088
    ds_read_b128 v[104:107], v8 offset:576
    v_cndmask_b32_dpp v208, v211, v209, vcc row_ror:8 row_mask:0xf bank_mask:0xf
    v_mov_b32_dpp v211, v209 row_ror:8 row_mask:0xf bank_mask:0x3
    s_waitcnt lgkmcnt(7)
    s_waitcnt lgkmcnt(6)
    v_mfma_f32_16x16x32_bf16 v[132:135], v[100:103], v[96:99], v[132:135]
    v_cndmask_b32_dpp v209, v214, v212, vcc row_ror:8 row_mask:0xf bank_mask:0xf
    v_mov_b32_dpp v214, v212 row_ror:8 row_mask:0xf bank_mask:0x3
    v_cndmask_b32_dpp v212, v215, v213, vcc row_ror:8 row_mask:0xf bank_mask:0xf
    v_mfma_f32_16x16x32_bf16 v[136:139], v[100:103], v[92:95], v[136:139]
    ds_read_b128 v[100:103], v8 offset:64
    ds_read_b128 v[92:95], v8 offset:0
    v_mov_b32_dpp v215, v213 row_ror:8 row_mask:0xf bank_mask:0x3
    v_cndmask_b32_dpp v213, v218, v216, vcc row_ror:8 row_mask:0xf bank_mask:0xf
    v_mov_b32_dpp v218, v216 row_ror:8 row_mask:0xf bank_mask:0x3
    s_waitcnt lgkmcnt(7)
    s_waitcnt lgkmcnt(6)
    v_mfma_f32_16x16x32_bf16 v[132:135], v[120:123], v[116:119], v[132:135]
    v_cndmask_b32_dpp v216, v219, v217, vcc row_ror:8 row_mask:0xf bank_mask:0xf
    v_mov_b32_dpp v219, v217 row_ror:8 row_mask:0xf bank_mask:0x3
    v_cndmask_b32_dpp v217, v222, v220, vcc row_ror:8 row_mask:0xf bank_mask:0xf
    v_mfma_f32_16x16x32_bf16 v[136:139], v[120:123], v[96:99], v[136:139]
    ds_read_b128 v[120:123], v9 offset:0
    ds_read_b128 v[96:99], v8 offset:512
    v_mov_b32_dpp v222, v220 row_ror:8 row_mask:0xf bank_mask:0x3
    v_cndmask_b32_dpp v220, v223, v221, vcc row_ror:8 row_mask:0xf bank_mask:0xf
    v_mov_b32_dpp v223, v221 row_ror:8 row_mask:0xf bank_mask:0x3
    s_waitcnt lgkmcnt(7)
    s_waitcnt lgkmcnt(6)
    v_mfma_f32_16x16x32_bf16 v[132:135], v[112:115], v[80:83], v[132:135]
    v_perm_b32 v192, v209, v17, s16
    v_perm_b32 v196, v209, v17, s17
    v_perm_b32 v200, v212, v208, s16
    v_mfma_f32_16x16x32_bf16 v[136:139], v[112:115], v[116:119], v[136:139]
    ds_read_b128 v[112:115], v9 offset:512
    ds_read_b128 v[116:119], v8 offset:1024
    v_perm_b32 v204, v212, v208, s17
    v_perm_b32 v193, v217, v213, s16
    v_perm_b32 v197, v217, v213, s17
    s_waitcnt lgkmcnt(7)
    v_mfma_f32_16x16x32_bf16 v[132:135], v[88:91], v[84:87], v[132:135]
    v_perm_b32 v201, v220, v216, s16
    v_perm_b32 v205, v220, v216, s17
    v_perm_b32 v194, v214, v210, s16
    v_mfma_f32_16x16x32_bf16 v[136:139], v[88:91], v[80:83], v[136:139]
    ds_read_b128 v[88:91], v9 offset:1024
    ds_read_b128 v[80:83], v8 offset:1536
    v_perm_b32 v198, v214, v210, s17
    v_perm_b32 v202, v215, v211, s16
    v_perm_b32 v206, v215, v211, s17
    s_waitcnt lgkmcnt(8)
    v_mfma_f32_16x16x32_bf16 v[132:135], v[104:107], v[108:111], v[132:135]
    v_perm_b32 v195, v222, v218, s16
    v_perm_b32 v199, v222, v218, s17
    v_perm_b32 v203, v223, v219, s16
    v_mfma_f32_16x16x32_bf16 v[136:139], v[104:107], v[84:87], v[136:139]
    ds_read_b128 v[104:107], v9 offset:1536
    ds_read_b128 v[84:87], v8 offset:2048
    v_perm_b32 v207, v223, v219, s17
    s_waitcnt vmcnt(9)
    s_mov_b64 vcc, s[20:21]
    v_cndmask_b32_dpp v17, v226, v224, vcc row_ror:8 row_mask:0xf bank_mask:0xf
    s_waitcnt lgkmcnt(9)
    v_mfma_f32_16x16x32_bf16 v[136:139], v[100:103], v[108:111], v[136:139]
    ds_read_b128 v[100:103], v9 offset:2048
    ds_read_b128 v[108:111], v8 offset:2560
    v_mov_b32_dpp v226, v224 row_ror:8 row_mask:0xf bank_mask:0x3
    v_cndmask_b32_dpp v224, v227, v225, vcc row_ror:8 row_mask:0xf bank_mask:0xf
    s_waitcnt lgkmcnt(10)
    s_waitcnt lgkmcnt(9)
    v_mfma_f32_16x16x32_bf16 v[136:139], v[92:95], v[120:123], v[136:139]
    ds_read_b128 v[92:95], v9 offset:2560
    s_waitcnt vmcnt(0)
    v_cmp_ne_u64 s[40:41], s[96:97], v[6:7]
    s_cmp_eq_u64 s[40:41], 0
    s_cselect_b32 s70, s70, 0
    buffer_load_dwordx4 v[32:35], v13, s[68:71], s48 offen offset:0 sc1
    s_waitcnt lgkmcnt(9)
    v_mfma_f32_16x16x32_bf16 v[132:135], v[96:99], v[120:123], v[132:135]
    buffer_load_dwordx4 v[36:39], v13, s[68:71], s48 offen offset:256 sc1
    s_waitcnt lgkmcnt(8)
    v_mfma_f32_16x16x32_bf16 v[136:139], v[96:99], v[112:115], v[136:139]
    ds_read_b128 v[96:99], v8 offset:3072
    buffer_load_dwordx4 v[40:43], v29, s[68:71], s48 offen offset:0 sc1
    v_mov_b32_dpp v227, v225 row_ror:8 row_mask:0xf bank_mask:0x3
    v_cndmask_b32_dpp v225, v230, v228, vcc row_ror:8 row_mask:0xf bank_mask:0xf
    s_waitcnt lgkmcnt(8)
    v_mfma_f32_16x16x32_bf16 v[132:135], v[116:119], v[112:115], v[132:135]
    buffer_load_dwordx4 v[44:47], v29, s[68:71], s48 offen offset:256 sc1
    v_mov_b32_dpp v230, v228 row_ror:8 row_mask:0xf bank_mask:0x3
    v_cndmask_b32_dpp v228, v231, v229, vcc row_ror:8 row_mask:0xf bank_mask:0xf
    s_waitcnt lgkmcnt(7)
    v_mfma_f32_16x16x32_bf16 v[136:139], v[116:119], v[88:91], v[136:139]
    ds_read_b128 v[116:119], v9 offset:3072
    buffer_load_dwordx4 v[48:51], v13, s[68:71], s49 offen offset:0 sc1
    v_mov_b32_dpp v231, v229 row_ror:8 row_mask:0xf bank_mask:0x3
    v_cndmask_b32_dpp v229, v234, v232, vcc row_ror:8 row_mask:0xf bank_mask:0xf
    s_waitcnt lgkmcnt(7)
    v_mfma_f32_16x16x32_bf16 v[132:135], v[80:83], v[88:91], v[132:135]
    ds_read_b128 v[88:91], v8 offset:3584
    buffer_load_dwordx4 v[52:55], v13, s[68:71], s49 offen offset:256 sc1
    v_mov_b32_dpp v234, v232 row_ror:8 row_mask:0xf bank_mask:0x3
    v_cndmask_b32_dpp v232, v235, v233, vcc row_ror:8 row_mask:0xf bank_mask:0xf
    s_waitcnt lgkmcnt(7)
    v_mfma_f32_16x16x32_bf16 v[136:139], v[80:83], v[104:107], v[136:139]
    ds_read_b128 v[80:83], v9 offset:3584
    v_mov_b32_dpp v235, v233 row_ror:8 row_mask:0xf bank_mask:0x3
    v_cndmask_b32_dpp v233, v238, v236, vcc row_ror:8 row_mask:0xf bank_mask:0xf
    v_mov_b32_dpp v238, v236 row_ror:8 row_mask:0xf bank_mask:0x3
    s_waitcnt lgkmcnt(7)
    v_mfma_f32_16x16x32_bf16 v[132:135], v[84:87], v[104:107], v[132:135]
    v_cndmask_b32_dpp v236, v239, v237, vcc row_ror:8 row_mask:0xf bank_mask:0xf
    v_mov_b32_dpp v239, v237 row_ror:8 row_mask:0xf bank_mask:0x3
    v_perm_b32 v208, v225, v17, s16
    s_waitcnt lgkmcnt(6)
    v_mfma_f32_16x16x32_bf16 v[136:139], v[84:87], v[100:103], v[136:139]
    buffer_load_dwordx4 v[56:59], v29, s[68:71], s49 offen offset:0 sc1
    v_perm_b32 v212, v225, v17, s17
    v_perm_b32 v216, v228, v224, s16
    s_waitcnt lgkmcnt(5)
    v_mfma_f32_16x16x32_bf16 v[132:135], v[108:111], v[100:103], v[132:135]
    v_perm_b32 v220, v228, v224, s17
    v_perm_b32 v209, v233, v229, s16
    v_perm_b32 v213, v233, v229, s17
    s_waitcnt lgkmcnt(4)
    v_mfma_f32_16x16x32_bf16 v[136:139], v[108:111], v[92:95], v[136:139]
    v_perm_b32 v217, v236, v232, s16
    v_perm_b32 v221, v236, v232, s17
    v_perm_b32 v210, v230, v226, s16
    s_waitcnt lgkmcnt(3)
    v_mfma_f32_16x16x32_bf16 v[128:131], v[96:99], v[120:123], v[128:131]
    buffer_load_dwordx4 v[60:63], v29, s[68:71], s49 offen offset:256 sc1
    v_perm_b32 v214, v230, v226, s17
    v_perm_b32 v218, v231, v227, s16
    v_mfma_f32_16x16x32_bf16 v[132:135], v[96:99], v[92:95], v[132:135]
    v_perm_b32 v222, v231, v227, s17
    v_perm_b32 v211, v238, v234, s16
    v_perm_b32 v215, v238, v234, s17
    s_waitcnt lgkmcnt(2)
    v_mfma_f32_16x16x32_bf16 v[136:139], v[96:99], v[116:119], v[136:139]
    v_perm_b32 v219, v239, v235, s16
    v_perm_b32 v223, v239, v235, s17
    s_mov_b64 vcc, s[20:21]
    s_waitcnt lgkmcnt(1)
    v_mfma_f32_16x16x32_bf16 v[124:127], v[88:91], v[120:123], v[124:127]
    s_add_u32 m0, s31, 0
    s_nop 0
    buffer_load_dwordx4 v13, s[68:71], s50 offen offset:0 sc1 lds
    v_mfma_f32_16x16x32_bf16 v[128:131], v[88:91], v[112:115], v[128:131]
    v_cndmask_b32_dpp v17, v242, v240, vcc row_ror:8 row_mask:0xf bank_mask:0xf
    v_mov_b32_dpp v242, v240 row_ror:8 row_mask:0xf bank_mask:0x3
    v_cndmask_b32_dpp v240, v243, v241, vcc row_ror:8 row_mask:0xf bank_mask:0xf
    v_mfma_f32_16x16x32_bf16 v[132:135], v[88:91], v[116:119], v[132:135]
    v_mov_b32_dpp v243, v241 row_ror:8 row_mask:0xf bank_mask:0x3
    v_cndmask_b32_dpp v241, v246, v244, vcc row_ror:8 row_mask:0xf bank_mask:0xf
    v_mov_b32_dpp v246, v244 row_ror:8 row_mask:0xf bank_mask:0x3
    s_waitcnt lgkmcnt(0)
    v_mfma_f32_16x16x32_bf16 v[136:139], v[88:91], v[80:83], v[136:139]
    s_add_u32 m0, s31, 768
    s_nop 0
    buffer_load_dwordx4 v13, s[68:71], s50 offen offset:256 sc1 lds
    s_branch L_cv_join_10
L_cv_rs1_9:
    ds_read_b128 v[100:103], v8 offset:3776
    ds_read_b128 v[104:107], v9 offset:1216
    ds_read_b128 v[108:111], v9 offset:1728
    ds_read_b128 v[112:115], v9 offset:2240
    ds_read_b128 v[116:119], v9 offset:2752
    ds_read_b128 v[120:123], v8 offset:3264
    ds_read_b128 v[80:83], v9 offset:704
    ds_read_b128 v[84:87], v8 offset:2752
    ds_read_b128 v[88:91], v9 offset:192
    ds_read_b128 v[92:95], v8 offset:2240
    ds_read_b128 v[96:99], v8 offset:1728
    s_waitcnt lgkmcnt(10)
    s_waitcnt lgkmcnt(9)
    v_mfma_f32_16x16x32_bf16 v[124:127], v[100:103], v[104:107], 0
    buffer_load_dwordx4 v[216:219], v11, s[80:83], s58 offen offset:1792
    s_mov_b64 vcc, s[20:21]
    v_cndmask_b32_dpp v17, v162, v160, vcc row_ror:8 row_mask:0xf bank_mask:0xf
    s_waitcnt lgkmcnt(8)
    v_mfma_f32_16x16x32_bf16 v[128:131], v[100:103], v[108:111], 0
    v_mov_b32_dpp v162, v160 row_ror:8 row_mask:0xf bank_mask:0x3
    v_cndmask_b32_dpp v160, v163, v161, vcc row_ror:8 row_mask:0xf bank_mask:0xf
    v_mov_b32_dpp v163, v161 row_ror:8 row_mask:0xf bank_mask:0x3
    s_waitcnt lgkmcnt(7)
    v_mfma_f32_16x16x32_bf16 v[132:135], v[100:103], v[112:115], 0
    buffer_load_dwordx4 v[220:223], v11, s[80:83], s58 offen offset:2688
    v_cndmask_b32_dpp v161, v166, v164, vcc row_ror:8 row_mask:0xf bank_mask:0xf
    v_mov_b32_dpp v166, v164 row_ror:8 row_mask:0xf bank_mask:0x3
    s_waitcnt lgkmcnt(6)
    v_mfma_f32_16x16x32_bf16 v[136:139], v[100:103], v[116:119], 0
    ds_read_b128 v[100:103], v8 offset:1216
    ds_read_b128 v[116:119], v8 offset:1152
    v_cndmask_b32_dpp v164, v167, v165, vcc row_ror:8 row_mask:0xf bank_mask:0xf
    v_mov_b32_dpp v167, v165 row_ror:8 row_mask:0xf bank_mask:0x3
    v_cndmask_b32_dpp v165, v170, v168, vcc row_ror:8 row_mask:0xf bank_mask:0xf
    s_waitcnt lgkmcnt(7)
    s_waitcnt lgkmcnt(6)
    v_mfma_f32_16x16x32_bf16 v[124:127], v[120:123], v[80:83], v[124:127]
    s_cmp_ge_u32 s3, 4
    s_cbranch_scc0 L_afs_13
    s_waitcnt vmcnt(2)
    buffer_store_dwordx2 v[30:31], v28, s[72:75], s24 offen sc1
L_afs_13:
    buffer_load_dwordx4 v[224:227], v11, s[80:83], s59 offen offset:0
    v_mfma_f32_16x16x32_bf16 v[128:131], v[120:123], v[104:107], v[128:131]
    v_mfma_f32_16x16x32_bf16 v[132:135], v[120:123], v[108:111], v[132:135]
    buffer_load_dwordx4 v[228:231], v11, s[80:83], s59 offen offset:896
    v_mov_b32_dpp v170, v168 row_ror:8 row_mask:0xf bank_mask:0x3
    v_cndmask_b32_dpp v168, v171, v169, vcc row_ror:8 row_mask:0xf bank_mask:0xf
    v_mfma_f32_16x16x32_bf16 v[136:139], v[120:123], v[112:115], v[136:139]
    ds_read_b128 v[120:123], v9 offset:128
    ds_read_b128 v[112:115], v8 offset:1664
    v_mov_b32_dpp v171, v169 row_ror:8 row_mask:0xf bank_mask:0x3
    v_cndmask_b32_dpp v169, v174, v172, vcc row_ror:8 row_mask:0xf bank_mask:0xf
    v_mov_b32_dpp v174, v172 row_ror:8 row_mask:0xf bank_mask:0x3
    s_waitcnt lgkmcnt(7)
    s_waitcnt lgkmcnt(6)
    v_mfma_f32_16x16x32_bf16 v[124:127], v[84:87], v[88:91], v[124:127]
    buffer_load_dwordx4 v[232:235], v11, s[80:83], s59 offen offset:1792
    v_cndmask_b32_dpp v172, v175, v173, vcc row_ror:8 row_mask:0xf bank_mask:0xf
    v_mov_b32_dpp v175, v173 row_ror:8 row_mask:0xf bank_mask:0x3
    v_mfma_f32_16x16x32_bf16 v[128:131], v[84:87], v[80:83], v[128:131]
    v_perm_b32 v144, v161, v17, s16
    v_perm_b32 v148, v161, v17, s17
    v_perm_b32 v152, v164, v160, s16
    v_mfma_f32_16x16x32_bf16 v[132:135], v[84:87], v[104:107], v[132:135]
    buffer_load_dwordx4 v[236:239], v11, s[80:83], s59 offen offset:2688
    v_perm_b32 v156, v164, v160, s17
    v_perm_b32 v145, v169, v165, s16
    v_mfma_f32_16x16x32_bf16 v[136:139], v[84:87], v[108:111], v[136:139]
    ds_read_b128 v[84:87], v9 offset:640
    ds_read_b128 v[108:111], v8 offset:2176
    v_perm_b32 v149, v169, v165, s17
    v_perm_b32 v153, v172, v168, s16
    v_perm_b32 v157, v172, v168, s17
    s_waitcnt lgkmcnt(7)
    v_mfma_f32_16x16x32_bf16 v[128:131], v[92:95], v[88:91], v[128:131]
    buffer_load_dwordx4 v[240:243], v11, s[80:83], s64 offen offset:0
    v_perm_b32 v146, v166, v162, s16
    v_perm_b32 v150, v166, v162, s17
    v_mfma_f32_16x16x32_bf16 v[132:135], v[92:95], v[80:83], v[132:135]
    v_perm_b32 v154, v167, v163, s16
    v_perm_b32 v158, v167, v163, s17
    v_perm_b32 v147, v174, v170, s16
    v_mfma_f32_16x16x32_bf16 v[136:139], v[92:95], v[104:107], v[136:139]
    ds_read_b128 v[92:95], v9 offset:1152
    ds_read_b128 v[104:107], v8 offset:2688
    buffer_load_dwordx4 v[244:247], v11, s[80:83], s64 offen offset:896
    v_perm_b32 v151, v174, v170, s17
    v_perm_b32 v155, v175, v171, s16
    s_waitcnt lgkmcnt(8)
    v_mfma_f32_16x16x32_bf16 v[132:135], v[96:99], v[88:91], v[132:135]
    v_perm_b32 v159, v175, v171, s17
    s_mov_b64 vcc, s[20:21]
    v_cndmask_b32_dpp v17, v178, v176, vcc row_ror:8 row_mask:0xf bank_mask:0xf
    v_mfma_f32_16x16x32_bf16 v[136:139], v[96:99], v[80:83], v[136:139]
    ds_read_b128 v[96:99], v9 offset:1664
    ds_read_b128 v[80:83], v8 offset:3200
    buffer_load_dwordx4 v[248:251], v11, s[80:83], s64 offen offset:1792
    v_mov_b32_dpp v178, v176 row_ror:8 row_mask:0xf bank_mask:0x3
    v_cndmask_b32_dpp v176, v179, v177, vcc row_ror:8 row_mask:0xf bank_mask:0xf
    s_waitcnt lgkmcnt(9)
    v_mfma_f32_16x16x32_bf16 v[136:139], v[100:103], v[88:91], v[136:139]
    ds_read_b128 v[100:103], v9 offset:2176
    ds_read_b128 v[88:91], v8 offset:3712
    v_mov_b32_dpp v179, v177 row_ror:8 row_mask:0xf bank_mask:0x3
    v_cndmask_b32_dpp v177, v182, v180, vcc row_ror:8 row_mask:0xf bank_mask:0xf
    v_mov_b32_dpp v182, v180 row_ror:8 row_mask:0xf bank_mask:0x3
    s_waitcnt lgkmcnt(10)
    s_waitcnt lgkmcnt(9)
    v_mfma_f32_16x16x32_bf16 v[136:139], v[116:119], v[120:123], v[136:139]
    ds_read_b128 v[116:119], v9 offset:2688
    buffer_load_dwordx4 v[252:255], v11, s[80:83], s64 offen offset:2688
    v_cndmask_b32_dpp v180, v183, v181, vcc row_ror:8 row_mask:0xf bank_mask:0xf
    v_mov_b32_dpp v183, v181 row_ror:8 row_mask:0xf bank_mask:0x3
    s_waitcnt lgkmcnt(9)
    v_mfma_f32_16x16x32_bf16 v[132:135], v[112:115], v[120:123], v[132:135]
    v_cndmask_b32_dpp v181, v186, v184, vcc row_ror:8 row_mask:0xf bank_mask:0xf
    v_mov_b32_dpp v186, v184 row_ror:8 row_mask:0xf bank_mask:0x3
    v_cndmask_b32_dpp v184, v187, v185, vcc row_ror:8 row_mask:0xf bank_mask:0xf
    s_waitcnt lgkmcnt(8)
    v_mfma_f32_16x16x32_bf16 v[136:139], v[112:115], v[84:87], v[136:139]
    ds_read_b128 v[112:115], v8 offset:3648
    buffer_load_dwordx4 v[64:67], v11, s[80:83], s65 offen offset:0
    v_mov_b32_dpp v187, v185 row_ror:8 row_mask:0xf bank_mask:0x3
    v_cndmask_b32_dpp v185, v190, v188, vcc row_ror:8 row_mask:0xf bank_mask:0xf
    s_waitcnt lgkmcnt(8)
    v_mfma_f32_16x16x32_bf16 v[128:131], v[108:111], v[120:123], v[128:131]
    v_mov_b32_dpp v190, v188 row_ror:8 row_mask:0xf bank_mask:0x3
    v_cndmask_b32_dpp v188, v191, v189, vcc row_ror:8 row_mask:0xf bank_mask:0xf
    v_mov_b32_dpp v191, v189 row_ror:8 row_mask:0xf bank_mask:0x3
    v_mfma_f32_16x16x32_bf16 v[132:135], v[108:111], v[84:87], v[132:135]
    buffer_load_dwordx4 v[68:71], v11, s[80:83], s65 offen offset:896
    v_perm_b32 v160, v177, v17, s16
    v_perm_b32 v164, v177, v17, s17
    s_waitcnt lgkmcnt(7)
    v_mfma_f32_16x16x32_bf16 v[136:139], v[108:111], v[92:95], v[136:139]
    ds_read_b128 v[108:111], v9 offset:1088
    v_perm_b32 v168, v180, v176, s16
    v_perm_b32 v172, v180, v176, s17
    v_perm_b32 v161, v185, v181, s16
    s_waitcnt lgkmcnt(7)
    v_mfma_f32_16x16x32_bf16 v[124:127], v[104:107], v[120:123], v[124:127]
    ds_read_b128 v[120:123], v9 offset:1600
    buffer_load_dwordx4 v[72:75], v11, s[80:83], s65 offen offset:1792
    v_perm_b32 v165, v185, v181, s17
    v_perm_b32 v169, v188, v184, s16
    v_mfma_f32_16x16x32_bf16 v[128:131], v[104:107], v[84:87], v[128:131]
    v_perm_b32 v173, v188, v184, s17
    v_perm_b32 v162, v182, v178, s16
    v_perm_b32 v166, v182, v178, s17
    v_mfma_f32_16x16x32_bf16 v[132:135], v[104:107], v[92:95], v[132:135]
    buffer_load_dwordx4 v[76:79], v11, s[80:83], s65 offen offset:2688
    v_perm_b32 v170, v183, v179, s16
    v_perm_b32 v174, v183, v179, s17
    s_waitcnt lgkmcnt(7)
    v_mfma_f32_16x16x32_bf16 v[136:139], v[104:107], v[96:99], v[136:139]
    ds_read_b128 v[104:107], v9 offset:2112
    v_perm_b32 v163, v190, v186, s16
    v_perm_b32 v167, v190, v186, s17
    v_perm_b32 v171, v191, v187, s16
    s_waitcnt lgkmcnt(7)
    v_mfma_f32_16x16x32_bf16 v[124:127], v[80:83], v[84:87], v[124:127]
    ds_read_b128 v[84:87], v9 offset:2624
    v_perm_b32 v175, v191, v187, s17
    s_mov_b64 vcc, s[20:21]
    v_cndmask_b32_dpp v17, v194, v192, vcc row_ror:8 row_mask:0xf bank_mask:0xf
    v_mfma_f32_16x16x32_bf16 v[128:131], v[80:83], v[92:95], v[128:131]
    v_mov_b32_dpp v194, v192 row_ror:8 row_mask:0xf bank_mask:0x3
    v_cndmask_b32_dpp v192, v195, v193, vcc row_ror:8 row_mask:0xf bank_mask:0xf
    v_mov_b32_dpp v195, v193 row_ror:8 row_mask:0xf bank_mask:0x3
    v_mfma_f32_16x16x32_bf16 v[132:135], v[80:83], v[96:99], v[132:135]
    v_cndmask_b32_dpp v193, v198, v196, vcc row_ror:8 row_mask:0xf bank_mask:0xf
    v_mov_b32_dpp v198, v196 row_ror:8 row_mask:0xf bank_mask:0x3
    v_cndmask_b32_dpp v196, v199, v197, vcc row_ror:8 row_mask:0xf bank_mask:0xf
    s_waitcnt lgkmcnt(7)
    v_mfma_f32_16x16x32_bf16 v[136:139], v[80:83], v[100:103], v[136:139]
    ds_read_b128 v[80:83], v8 offset:3136
    v_mov_b32_dpp v199, v197 row_ror:8 row_mask:0xf bank_mask:0x3
    v_cndmask_b32_dpp v197, v202, v200, vcc row_ror:8 row_mask:0xf bank_mask:0xf
    v_mov_b32_dpp v202, v200 row_ror:8 row_mask:0xf bank_mask:0x3
    s_waitcnt lgkmcnt(7)
    v_mfma_f32_16x16x32_bf16 v[124:127], v[88:91], v[92:95], v[124:127]
    ds_read_b128 v[92:95], v9 offset:576
    v_cndmask_b32_dpp v200, v203, v201, vcc row_ror:8 row_mask:0xf bank_mask:0xf
    v_mov_b32_dpp v203, v201 row_ror:8 row_mask:0xf bank_mask:0x3
    v_cndmask_b32_dpp v201, v206, v204, vcc row_ror:8 row_mask:0xf bank_mask:0xf
    v_mfma_f32_16x16x32_bf16 v[128:131], v[88:91], v[96:99], v[128:131]
    ds_read_b128 v[96:99], v8 offset:2624
    v_mov_b32_dpp v206, v204 row_ror:8 row_mask:0xf bank_mask:0x3
    v_cndmask_b32_dpp v204, v207, v205, vcc row_ror:8 row_mask:0xf bank_mask:0xf
    v_mov_b32_dpp v207, v205 row_ror:8 row_mask:0xf bank_mask:0x3
    v_mfma_f32_16x16x32_bf16 v[132:135], v[88:91], v[100:103], v[132:135]
    ds_read_b128 v[100:103], v9 offset:64
    v_perm_b32 v176, v193, v17, s16
    v_perm_b32 v180, v193, v17, s17
    v_perm_b32 v184, v196, v192, s16
    s_waitcnt lgkmcnt(9)
    v_mfma_f32_16x16x32_bf16 v[136:139], v[88:91], v[116:119], v[136:139]
    ds_read_b128 v[88:91], v8 offset:2112
    ds_read_b128 v[116:119], v8 offset:1600
    v_perm_b32 v188, v196, v192, s17
    v_perm_b32 v177, v201, v197, s16
    v_perm_b32 v181, v201, v197, s17
    s_waitcnt lgkmcnt(10)
    s_waitcnt lgkmcnt(9)
    v_mfma_f32_16x16x32_bf16 v[124:127], v[112:115], v[108:111], v[124:127]
    s_cmp_ge_u32 s3, 4
    s_cbranch_scc0 L_pr_14
    s_setprio 0
L_pr_14:
    s_waitcnt lgkmcnt(8)
    v_mfma_f32_16x16x32_bf16 v[128:131], v[112:115], v[120:123], v[128:131]
    v_perm_b32 v185, v204, v200, s16
    v_perm_b32 v189, v204, v200, s17
    s_waitcnt lgkmcnt(7)
    v_mfma_f32_16x16x32_bf16 v[132:135], v[112:115], v[104:107], v[132:135]
    v_perm_b32 v178, v198, v194, s16
    v_perm_b32 v182, v198, v194, s17
    v_perm_b32 v186, v199, v195, s16
    s_waitcnt lgkmcnt(6)
    v_mfma_f32_16x16x32_bf16 v[136:139], v[112:115], v[84:87], v[136:139]
    ds_read_b128 v[112:115], v8 offset:1088
    ds_read_b128 v[84:87], v8 offset:1024
    v_perm_b32 v190, v199, v195, s17
    v_perm_b32 v179, v206, v202, s16
    v_perm_b32 v183, v206, v202, s17
    s_waitcnt lgkmcnt(7)
    s_waitcnt lgkmcnt(6)
    v_mfma_f32_16x16x32_bf16 v[124:127], v[80:83], v[92:95], v[124:127]
    buffer_load_dwordx2 v[6:7], v12, s[72:75], 0 offen sc1
    v_perm_b32 v187, v207, v203, s16
    v_perm_b32 v191, v207, v203, s17
    v_mfma_f32_16x16x32_bf16 v[128:131], v[80:83], v[108:111], v[128:131]
    s_waitcnt vmcnt(13)
    s_mov_b64 vcc, s[20:21]
    v_cndmask_b32_dpp v17, v210, v208, vcc row_ror:8 row_mask:0xf bank_mask:0xf
    v_mov_b32_dpp v210, v208 row_ror:8 row_mask:0xf bank_mask:0x3
    v_mfma_f32_16x16x32_bf16 v[132:135], v[80:83], v[120:123], v[132:135]
    v_cndmask_b32_dpp v208, v211, v209, vcc row_ror:8 row_mask:0xf bank_mask:0xf
    v_mov_b32_dpp v211, v209 row_ror:8 row_mask:0xf bank_mask:0x3
    v_mfma_f32_16x16x32_bf16 v[136:139], v[80:83], v[104:107], v[136:139]
    ds_read_b128 v[80:83], v9 offset:0
    ds_read_b128 v[104:107], v8 offset:1536
    v_cndmask_b32_dpp v209, v214, v212, vcc row_ror:8 row_mask:0xf bank_mask:0xf
    v_mov_b32_dpp v214, v212 row_ror:8 row_mask:0xf bank_mask:0x3
    v_cndmask_b32_dpp v212, v215, v213, vcc row_ror:8 row_mask:0xf bank_mask:0xf
    s_waitcnt lgkmcnt(7)
    s_waitcnt lgkmcnt(6)
    v_mfma_f32_16x16x32_bf16 v[124:127], v[96:99], v[100:103], v[124:127]
    v_mov_b32_dpp v215, v213 row_ror:8 row_mask:0xf bank_mask:0x3
    v_cndmask_b32_dpp v213, v218, v216, vcc row_ror:8 row_mask:0xf bank_mask:0xf
    v_mov_b32_dpp v218, v216 row_ror:8 row_mask:0xf bank_mask:0x3
    v_mfma_f32_16x16x32_bf16 v[128:131], v[96:99], v[92:95], v[128:131]
    v_cndmask_b32_dpp v216, v219, v217, vcc row_ror:8 row_mask:0xf bank_mask:0xf
    v_mov_b32_dpp v219, v217 row_ror:8 row_mask:0xf bank_mask:0x3
    v_cndmask_b32_dpp v217, v222, v220, vcc row_ror:8 row_mask:0xf bank_mask:0xf
    v_mfma_f32_16x16x32_bf16 v[132:135], v[96:99], v[108:111], v[132:135]
    v_mov_b32_dpp v222, v220 row_ror:8 row_mask:0xf bank_mask:0x3
    v_cndmask_b32_dpp v220, v223, v221, vcc row_ror:8 row_mask:0xf bank_mask:0xf
    v_mov_b32_dpp v223, v221 row_ror:8 row_mask:0xf bank_mask:0x3
    v_mfma_f32_16x16x32_bf16 v[136:139], v[96:99], v[120:123], v[136:139]
    ds_read_b128 v[96:99], v9 offset:512
    ds_read_b128 v[120:123], v8 offset:2048
    v_perm_b32 v192, v209, v17, s16
    v_perm_b32 v196, v209, v17, s17
    v_perm_b32 v200, v212, v208, s16
    s_waitcnt lgkmcnt(7)
    v_mfma_f32_16x16x32_bf16 v[128:131], v[88:91], v[100:103], v[128:131]
    v_perm_b32 v204, v212, v208, s17
    v_perm_b32 v193, v217, v213, s16
    v_perm_b32 v197, v217, v213, s17
    v_mfma_f32_16x16x32_bf16 v[132:135], v[88:91], v[92:95], v[132:135]
    v_perm_b32 v201, v220, v216, s16
    v_perm_b32 v205, v220, v216, s17
    v_perm_b32 v194, v214, v210, s16
    v_mfma_f32_16x16x32_bf16 v[136:139], v[88:91], v[108:111], v[136:139]
    ds_read_b128 v[88:91], v9 offset:1024
    ds_read_b128 v[108:111], v8 offset:2560
    v_perm_b32 v198, v214, v210, s17
    v_perm_b32 v202, v215, v211, s16
    v_perm_b32 v206, v215, v211, s17
    s_waitcnt lgkmcnt(8)
    v_mfma_f32_16x16x32_bf16 v[132:135], v[116:119], v[100:103], v[132:135]
    v_perm_b32 v195, v222, v218, s16
    v_perm_b32 v199, v222, v218, s17
    v_perm_b32 v203, v223, v219, s16
    v_mfma_f32_16x16x32_bf16 v[136:139], v[116:119], v[92:95], v[136:139]
    ds_read_b128 v[116:119], v9 offset:1536
    ds_read_b128 v[92:95], v8 offset:3072
    v_perm_b32 v207, v223, v219, s17
    s_waitcnt vmcnt(9)
    s_mov_b64 vcc, s[20:21]
    v_cndmask_b32_dpp v17, v226, v224, vcc row_ror:8 row_mask:0xf bank_mask:0xf
    s_waitcnt lgkmcnt(9)
    v_mfma_f32_16x16x32_bf16 v[136:139], v[112:115], v[100:103], v[136:139]
    ds_read_b128 v[112:115], v9 offset:2048
    ds_read_b128 v[100:103], v8 offset:3584
    v_mov_b32_dpp v226, v224 row_ror:8 row_mask:0xf bank_mask:0x3
    v_cndmask_b32_dpp v224, v227, v225, vcc row_ror:8 row_mask:0xf bank_mask:0xf
    s_waitcnt lgkmcnt(10)
    s_waitcnt lgkmcnt(9)
    v_mfma_f32_16x16x32_bf16 v[136:139], v[84:87], v[80:83], v[136:139]
    ds_read_b128 v[84:87], v9 offset:2560
    s_waitcnt vmcnt(0)
    v_cmp_ne_u64 s[40:41], s[96:97], v[6:7]
    s_cmp_eq_u64 s[40:41], 0
    s_cselect_b32 s70, s70, 0
    buffer_load_dwordx4 v[32:35], v13, s[68:71], s48 offen offset:0 sc1
    s_waitcnt lgkmcnt(9)
    v_mfma_f32_16x16x32_bf16 v[132:135], v[104:107], v[80:83], v[132:135]
    buffer_load_dwordx4 v[36:39], v13, s[68:71], s48 offen offset:256 sc1
    s_waitcnt lgkmcnt(8)
    v_mfma_f32_16x16x32_bf16 v[136:139], v[104:107], v[96:99], v[136:139]
    buffer_load_dwordx4 v[40:43], v29, s[68:71], s48 offen offset:0 sc1
    v_mov_b32_dpp v227, v225 row_ror:8 row_mask:0xf bank_mask:0x3
    v_cndmask_b32_dpp v225, v230, v228, vcc row_ror:8 row_mask:0xf bank_mask:0xf
    s_waitcnt lgkmcnt(7)
    v_mfma_f32_16x16x32_bf16 v[128:131], v[120:123], v[80:83], v[128:131]
    buffer_load_dwordx4 v[44:47], v29, s[68:71], s48 offen offset:256 sc1
    v_mov_b32_dpp v230, v228 row_ror:8 row_mask:0xf bank_mask:0x3
    v_cndmask_b32_dpp v228, v231, v229, vcc row_ror:8 row_mask:0xf bank_mask:0xf
    v_mfma_f32_16x16x32_bf16 v[132:135], v[120:123], v[96:99], v[132:135]
    buffer_load_dwordx4 v[48:51], v13, s[68:71], s49 offen offset:0 sc1
    v_mov_b32_dpp v231, v229 row_ror:8 row_mask:0xf bank_mask:0x3
    v_cndmask_b32_dpp v229, v234, v232, vcc row_ror:8 row_mask:0xf bank_mask:0xf
    s_waitcnt lgkmcnt(6)
    v_mfma_f32_16x16x32_bf16 v[136:139], v[120:123], v[88:91], v[136:139]
    buffer_load_dwordx4 v[52:55], v13, s[68:71], s49 offen offset:256 sc1
    v_mov_b32_dpp v234, v232 row_ror:8 row_mask:0xf bank_mask:0x3
    v_cndmask_b32_dpp v232, v235, v233, vcc row_ror:8 row_mask:0xf bank_mask:0xf
    s_waitcnt lgkmcnt(5)
    v_mfma_f32_16x16x32_bf16 v[124:127], v[108:111], v[80:83], v[124:127]
    v_mov_b32_dpp v235, v233 row_ror:8 row_mask:0xf bank_mask:0x3
    v_cndmask_b32_dpp v233, v238, v236, vcc row_ror:8 row_mask:0xf bank_mask:0xf
    v_mov_b32_dpp v238, v236 row_ror:8 row_mask:0xf bank_mask:0x3
    v_mfma_f32_16x16x32_bf16 v[128:131], v[108:111], v[96:99], v[128:131]
    v_cndmask_b32_dpp v236, v239, v237, vcc row_ror:8 row_mask:0xf bank_mask:0xf
    v_mov_b32_dpp v239, v237 row_ror:8 row_mask:0xf bank_mask:0x3
    v_perm_b32 v208, v225, v17, s16
    v_mfma_f32_16x16x32_bf16 v[132:135], v[108:111], v[88:91], v[132:135]
    buffer_load_dwordx4 v[56:59], v29, s[68:71], s49 offen offset:0 sc1
    v_perm_b32 v212, v225, v17, s17
    v_perm_b32 v216, v228, v224, s16
    s_waitcnt lgkmcnt(4)
    v_mfma_f32_16x16x32_bf16 v[136:139], v[108:111], v[116:119], v[136:139]
    v_perm_b32 v220, v228, v224, s17
    v_perm_b32 v209, v233, v229, s16
    v_perm_b32 v213, v233, v229, s17
    s_waitcnt lgkmcnt(3)
    v_mfma_f32_16x16x32_bf16 v[124:127], v[92:95], v[96:99], v[124:127]
    v_perm_b32 v217, v236, v232, s16
    v_perm_b32 v221, v236, v232, s17
    v_perm_b32 v210, v230, v226, s16
    v_mfma_f32_16x16x32_bf16 v[128:131], v[92:95], v[88:91], v[128:131]
    buffer_load_dwordx4 v[60:63], v29, s[68:71], s49 offen offset:256 sc1
    v_perm_b32 v214, v230, v226, s17
    v_perm_b32 v218, v231, v227, s16
    v_mfma_f32_16x16x32_bf16 v[132:135], v[92:95], v[116:119], v[132:135]
    v_perm_b32 v222, v231, v227, s17
    v_perm_b32 v211, v238, v234, s16
    v_perm_b32 v215, v238, v234, s17
    s_waitcnt lgkmcnt(2)
    v_mfma_f32_16x16x32_bf16 v[136:139], v[92:95], v[112:115], v[136:139]
    v_perm_b32 v219, v239, v235, s16
    v_perm_b32 v223, v239, v235, s17
    s_mov_b64 vcc, s[20:21]
    s_waitcnt lgkmcnt(1)
    v_mfma_f32_16x16x32_bf16 v[124:127], v[100:103], v[88:91], v[124:127]
    s_add_u32 m0, s31, 0
    s_nop 0
    buffer_load_dwordx4 v13, s[68:71], s50 offen offset:0 sc1 lds
    v_mfma_f32_16x16x32_bf16 v[128:131], v[100:103], v[116:119], v[128:131]
    v_cndmask_b32_dpp v17, v242, v240, vcc row_ror:8 row_mask:0xf bank_mask:0xf
    v_mov_b32_dpp v242, v240 row_ror:8 row_mask:0xf bank_mask:0x3
    v_cndmask_b32_dpp v240, v243, v241, vcc row_ror:8 row_mask:0xf bank_mask:0xf
    v_mfma_f32_16x16x32_bf16 v[132:135], v[100:103], v[112:115], v[132:135]
    v_mov_b32_dpp v243, v241 row_ror:8 row_mask:0xf bank_mask:0x3
    v_cndmask_b32_dpp v241, v246, v244, vcc row_ror:8 row_mask:0xf bank_mask:0xf
    v_mov_b32_dpp v246, v244 row_ror:8 row_mask:0xf bank_mask:0x3
    s_waitcnt lgkmcnt(0)
    v_mfma_f32_16x16x32_bf16 v[136:139], v[100:103], v[84:87], v[136:139]
    s_add_u32 m0, s31, 768
    s_nop 0
    buffer_load_dwordx4 v13, s[68:71], s50 offen offset:256 sc1 lds
L_cv_join_10:
    ds_read_b64 v[88:89], v16 offset:512
    ds_read_b64 v[90:91], v16
    s_bitcmp1_b32 s3, 1
    s_nop 3
    s_cbranch_scc1 L_cv_cs1_15
    ds_write_b128 v15, v[132:135]
    ds_write_b128 v15, v[136:139] offset:1024
    s_branch L_cv_j2_16
L_cv_cs1_15:
    ds_write_b128 v15, v[124:127]
    ds_write_b128 v15, v[128:131] offset:1024
    s_nop 1
    v_mov_b32 v124, v132
    v_mov_b32 v125, v133
    v_mov_b32 v126, v134
    v_mov_b32 v127, v135
    v_mov_b32 v128, v136
    v_mov_b32 v129, v137
    v_mov_b32 v130, v138
    v_mov_b32 v131, v139
L_cv_j2_16:
    s_add_u32 m0, s31, 2048
    s_nop 0
    buffer_load_dwordx4 v29, s[68:71], s50 offen offset:0 sc1 lds
    s_waitcnt lgkmcnt(2)
    v_and_b32 v96, 0xffff0000, v89
    v_lshlrev_b32 v97, 16, v89
    v_and_b32 v98, 0xffff0000, v88
    v_lshlrev_b32 v99, 16, v88
    v_and_b32 v100, 0xffff0000, v91
    v_lshlrev_b32 v101, 16, v91
    v_and_b32 v102, 0xffff0000, v90
    v_lshlrev_b32 v103, 16, v90
    s_waitcnt lgkmcnt(0)
    s_barrier
    ds_read_b128 v[80:83], v14 offset:16384
    ds_read_b128 v[84:87], v14 offset:17408
    s_add_u32 m0, s31, 2816
    s_nop 0
    buffer_load_dwordx4 v29, s[68:71], s50 offen offset:256 sc1 lds
    v_fmac_f32 v124, s35, v96
    v_fmac_f32 v125, s35, v97
    v_fmac_f32 v126, s35, v98
    v_fmac_f32 v127, s35, v99
    v_fmac_f32 v128, s35, v100
    v_fmac_f32 v129, s35, v101
    v_fmac_f32 v130, s35, v102
    v_fmac_f32 v131, s35, v103
    v_add_u32 v8, 0x10000, v27
    s_waitcnt lgkmcnt(0)
    v_add_f32 v124, v124, v80
    v_add_f32 v125, v125, v81
    v_add_f32 v126, v126, v82
    v_add_f32 v127, v127, v83
    v_cvt_pk_bf16_f32 v92, v124, v125
    v_cvt_pk_bf16_f32 v93, v126, v127
    v_add_f32 v128, v128, v84
    v_add_f32 v129, v129, v85
    v_add_f32 v130, v130, v86
    v_add_f32 v131, v131, v87
    v_cvt_pk_bf16_f32 v94, v128, v129
    v_cvt_pk_bf16_f32 v95, v130, v131
    s_nop 1
    v_permlane16_swap_b32 v92, v94
    v_permlane16_swap_b32 v93, v95
    s_nop 1
    buffer_store_dwordx4 v[92:95], v18, s[72:75], s33 offen sc1
    s_add_u32 m0, s31, 4096
    s_nop 0
    buffer_load_dwordx4 v13, s[68:71], s51 offen offset:0 sc1 lds
    s_add_u32 m0, s31, 4864
    s_nop 0
    buffer_load_dwordx4 v13, s[68:71], s51 offen offset:256 sc1 lds
    s_cmp_lg_u32 s70, 0
    s_cbranch_scc1 L_apfast_17
    s_waitcnt vmcnt(2)
    buffer_store_dwordx2 v[30:31], v28, s[72:75], s25 offen sc1
    s_mov_b32 s36, 1
    v_cmp_ne_u64 s[40:41], s[96:97], v[6:7]
    s_cmp_lg_u64 s[40:41], 0
    s_cbranch_scc0 L_pok_18
L_pre_19:
    s_cmp_eq_u32 s19, 0
    s_cbranch_scc1 L_pok_18
    s_sub_u32 s19, s19, 1
    s_sleep 2
    buffer_load_dwordx2 v[6:7], v12, s[72:75], 0 offen sc1
    s_waitcnt vmcnt(0)
    v_cmp_ne_u64 s[40:41], s[96:97], v[6:7]
    s_cmp_lg_u64 s[40:41], 0
    s_cbranch_scc1 L_pre_19
L_pok_18:
    s_mov_b32 s70, 33554432
    buffer_load_dwordx4 v[32:35], v13, s[68:71], s48 offen offset:0 sc1
    buffer_load_dwordx4 v[36:39], v13, s[68:71], s48 offen offset:256 sc1
    buffer_load_dwordx4 v[40:43], v29, s[68:71], s48 offen offset:0 sc1
    buffer_load_dwordx4 v[44:47], v29, s[68:71], s48 offen offset:256 sc1
    buffer_load_dwordx4 v[48:51], v13, s[68:71], s49 offen offset:0 sc1
    buffer_load_dwordx4 v[52:55], v13, s[68:71], s49 offen offset:256 sc1
    buffer_load_dwordx4 v[56:59], v29, s[68:71], s49 offen offset:0 sc1
    buffer_load_dwordx4 v[60:63], v29, s[68:71], s49 offen offset:256 sc1
    s_add_u32 m0, s31, 0
    s_nop 0
    buffer_load_dwordx4 v13, s[68:71], s50 offen offset:0 sc1 lds
    s_add_u32 m0, s31, 768
    s_nop 0
    buffer_load_dwordx4 v13, s[68:71], s50 offen offset:256 sc1 lds
    s_add_u32 m0, s31, 2048
    s_nop 0
    buffer_load_dwordx4 v29, s[68:71], s50 offen offset:0 sc1 lds
    s_add_u32 m0, s31, 2816
    s_nop 0
    buffer_load_dwordx4 v29, s[68:71], s50 offen offset:256 sc1 lds
    s_add_u32 m0, s31, 4096
    s_nop 0
    buffer_load_dwordx4 v13, s[68:71], s51 offen offset:0 sc1 lds
    s_add_u32 m0, s31, 4864
    s_nop 0
    buffer_load_dwordx4 v13, s[68:71], s51 offen offset:256 sc1 lds
L_apfast_17:
    s_nop 1
    s_waitcnt vmcnt(13)
    v_mfma_f32_16x16x32_bf16 v[80:83], v[32:35], v[144:147], 0
    v_cndmask_b32_dpp v244, v247, v245, vcc row_ror:8 row_mask:0xf bank_mask:0xf
    v_mov_b32_dpp v247, v245 row_ror:8 row_mask:0xf bank_mask:0x3
    v_cndmask_b32_dpp v245, v250, v248, vcc row_ror:8 row_mask:0xf bank_mask:0xf
    v_mov_b32_dpp v250, v248 row_ror:8 row_mask:0xf bank_mask:0x3
    v_mfma_f32_16x16x32_bf16 v[84:87], v[32:35], v[148:151], 0
    v_cndmask_b32_dpp v248, v251, v249, vcc row_ror:8 row_mask:0xf bank_mask:0xf
    v_mov_b32_dpp v251, v249 row_ror:8 row_mask:0xf bank_mask:0x3
    v_cndmask_b32_dpp v249, v254, v252, vcc row_ror:8 row_mask:0xf bank_mask:0xf
    v_mov_b32_dpp v254, v252 row_ror:8 row_mask:0xf bank_mask:0x3
    v_mfma_f32_16x16x32_bf16 v[88:91], v[32:35], v[152:155], 0
    v_cndmask_b32_dpp v252, v255, v253, vcc row_ror:8 row_mask:0xf bank_mask:0xf
    v_mov_b32_dpp v255, v253 row_ror:8 row_mask:0xf bank_mask:0x3
    v_perm_b32 v224, v241, v17, s16
    v_perm_b32 v228, v241, v17, s17
    v_mfma_f32_16x16x32_bf16 v[92:95], v[32:35], v[156:159], 0
    v_perm_b32 v232, v244, v240, s16
    v_perm_b32 v236, v244, v240, s17
    v_perm_b32 v225, v249, v245, s16
    v_perm_b32 v229, v249, v245, s17
    s_waitcnt vmcnt(12)
    v_mfma_f32_16x16x32_bf16 v[96:99], v[36:39], v[144:147], 0
    v_perm_b32 v233, v252, v248, s16
    v_perm_b32 v237, v252, v248, s17
    v_perm_b32 v226, v246, v242, s16
    v_perm_b32 v230, v246, v242, s17
    v_mfma_f32_16x16x32_bf16 v[100:103], v[36:39], v[148:151], 0
    v_perm_b32 v234, v247, v243, s16
    v_perm_b32 v238, v247, v243, s17
    v_perm_b32 v227, v254, v250, s16
    v_perm_b32 v231, v254, v250, s17
    v_mfma_f32_16x16x32_bf16 v[104:107], v[36:39], v[152:155], 0
    v_perm_b32 v235, v255, v251, s16
    v_perm_b32 v239, v255, v251, s17
    s_mov_b64 vcc, s[20:21]
    v_cndmask_b32_dpp v17, v66, v64, vcc row_ror:8 row_mask:0xf bank_mask:0xf
    v_mfma_f32_16x16x32_bf16 v[108:111], v[36:39], v[156:159], 0
    v_mov_b32_dpp v66, v64 row_ror:8 row_mask:0xf bank_mask:0x3
    v_cndmask_b32_dpp v64, v67, v65, vcc row_ror:8 row_mask:0xf bank_mask:0xf
    v_mov_b32_dpp v67, v65 row_ror:8 row_mask:0xf bank_mask:0x3
    v_cndmask_b32_dpp v65, v70, v68, vcc row_ror:8 row_mask:0xf bank_mask:0xf
    s_waitcnt vmcnt(11)
    v_mfma_f32_16x16x32_bf16 v[112:115], v[40:43], v[144:147], 0
    v_mov_b32_dpp v70, v68 row_ror:8 row_mask:0xf bank_mask:0x3
    v_cndmask_b32_dpp v68, v71, v69, vcc row_ror:8 row_mask:0xf bank_mask:0xf
    v_mov_b32_dpp v71, v69 row_ror:8 row_mask:0xf bank_mask:0x3
    v_cndmask_b32_dpp v69, v74, v72, vcc row_ror:8 row_mask:0xf bank_mask:0xf
    v_mfma_f32_16x16x32_bf16 v[116:119], v[40:43], v[148:151], 0
    v_mov_b32_dpp v74, v72 row_ror:8 row_mask:0xf bank_mask:0x3
    v_cndmask_b32_dpp v72, v75, v73, vcc row_ror:8 row_mask:0xf bank_mask:0xf
    v_mov_b32_dpp v75, v73 row_ror:8 row_mask:0xf bank_mask:0x3
    v_cndmask_b32_dpp v73, v78, v76, vcc row_ror:8 row_mask:0xf bank_mask:0xf
    v_mfma_f32_16x16x32_bf16 v[120:123], v[40:43], v[152:155], 0
    v_mov_b32_dpp v78, v76 row_ror:8 row_mask:0xf bank_mask:0x3
    v_cndmask_b32_dpp v76, v79, v77, vcc row_ror:8 row_mask:0xf bank_mask:0xf
    v_mov_b32_dpp v79, v77 row_ror:8 row_mask:0xf bank_mask:0x3
    v_perm_b32 v240, v65, v17, s16
    v_mfma_f32_16x16x32_bf16 v[124:127], v[40:43], v[156:159], 0
    v_perm_b32 v244, v65, v17, s17
    v_perm_b32 v248, v68, v64, s16
    v_perm_b32 v252, v68, v64, s17
    v_perm_b32 v241, v73, v69, s16
    s_waitcnt vmcnt(10)
    v_mfma_f32_16x16x32_bf16 v[128:131], v[44:47], v[144:147], 0
    v_perm_b32 v245, v73, v69, s17
    v_perm_b32 v249, v76, v72, s16
    v_perm_b32 v253, v76, v72, s17
    v_perm_b32 v242, v70, v66, s16
    v_mfma_f32_16x16x32_bf16 v[132:135], v[44:47], v[148:151], 0
    v_perm_b32 v246, v70, v66, s17
    v_perm_b32 v250, v71, v67, s16
    v_perm_b32 v254, v71, v67, s17
    v_perm_b32 v243, v78, v74, s16
    v_mfma_f32_16x16x32_bf16 v[136:139], v[44:47], v[152:155], 0
    v_perm_b32 v247, v78, v74, s17
    v_perm_b32 v251, v79, v75, s16
    v_perm_b32 v255, v79, v75, s17
    v_mfma_f32_16x16x32_bf16 v[140:143], v[44:47], v[156:159], 0
    s_add_u32 m0, s31, 6144
    s_nop 0
    buffer_load_dwordx4 v29, s[68:71], s51 offen offset:0 sc1 lds
    s_waitcnt vmcnt(10)
    v_mfma_f32_16x16x32_bf16 v[80:83], v[48:51], v[160:163], v[80:83]
    v_mfma_f32_16x16x32_bf16 v[84:87], v[48:51], v[164:167], v[84:87]
    v_mfma_f32_16x16x32_bf16 v[88:91], v[48:51], v[168:171], v[88:91]
    v_mfma_f32_16x16x32_bf16 v[92:95], v[48:51], v[172:175], v[92:95]
    s_add_u32 m0, s31, 6912
    s_nop 0
    buffer_load_dwordx4 v29, s[68:71], s51 offen offset:256 sc1 lds
    s_cmp_lg_u32 s36, 0
    s_cbranch_scc1 L_yfs_20
    s_waitcnt vmcnt(4)
    buffer_store_dwordx2 v[30:31], v28, s[72:75], s25 offen sc1
L_yfs_20:
    s_waitcnt vmcnt(7)
    ds_read_b128 v[32:35], v27 offset:0
    v_mfma_f32_16x16x32_bf16 v[96:99], v[52:55], v[160:163], v[96:99]
    v_mfma_f32_16x16x32_bf16 v[100:103], v[52:55], v[164:167], v[100:103]
    v_mfma_f32_16x16x32_bf16 v[104:107], v[52:55], v[168:171], v[104:107]
    v_mfma_f32_16x16x32_bf16 v[108:111], v[52:55], v[172:175], v[108:111]
    s_add_u32 m0, s31, 65536
    s_nop 0
    buffer_load_dwordx4 v13, s[68:71], s52 offen offset:0 sc1 lds
    s_waitcnt vmcnt(7)
    ds_read_b128 v[36:39], v27 offset:1024
    v_mfma_f32_16x16x32_bf16 v[112:115], v[56:59], v[160:163], v[112:115]
    v_mfma_f32_16x16x32_bf16 v[116:119], v[56:59], v[164:167], v[116:119]
    v_mfma_f32_16x16x32_bf16 v[120:123], v[56:59], v[168:171], v[120:123]
    v_mfma_f32_16x16x32_bf16 v[124:127], v[56:59], v[172:175], v[124:127]
    s_add_u32 m0, s31, 66304
    s_nop 0
    buffer_load_dwordx4 v13, s[68:71], s52 offen offset:256 sc1 lds
    s_waitcnt vmcnt(7)
    ds_read_b128 v[40:43], v27 offset:2048
    v_mfma_f32_16x16x32_bf16 v[128:131], v[60:63], v[160:163], v[128:131]
    v_mfma_f32_16x16x32_bf16 v[132:135], v[60:63], v[164:167], v[132:135]
    v_mfma_f32_16x16x32_bf16 v[136:139], v[60:63], v[168:171], v[136:139]
    v_mfma_f32_16x16x32_bf16 v[140:143], v[60:63], v[172:175], v[140:143]
    s_add_u32 m0, s31, 67584
    s_nop 0
    buffer_load_dwordx4 v29, s[68:71], s52 offen offset:0 sc1 lds
    s_waitcnt vmcnt(7)
    ds_read_b128 v[44:47], v27 offset:3072
    s_waitcnt lgkmcnt(3)
    v_mfma_f32_16x16x32_bf16 v[80:83], v[32:35], v[176:179], v[80:83]
    v_mfma_f32_16x16x32_bf16 v[84:87], v[32:35], v[180:183], v[84:87]
    v_mfma_f32_16x16x32_bf16 v[88:91], v[32:35], v[184:187], v[88:91]
    v_mfma_f32_16x16x32_bf16 v[92:95], v[32:35], v[188:191], v[92:95]
    s_add_u32 m0, s31, 68352
    s_nop 0
    buffer_load_dwordx4 v29, s[68:71], s52 offen offset:256 sc1 lds
    s_waitcnt vmcnt(7)
    ds_read_b128 v[48:51], v27 offset:4096
    s_waitcnt lgkmcnt(3)
    v_mfma_f32_16x16x32_bf16 v[96:99], v[36:39], v[176:179], v[96:99]
    v_mov_b32 v152, 0
    v_mov_b32 v153, 0
    v_mov_b32 v154, 0
    v_mov_b32 v155, 0
    v_mfma_f32_16x16x32_bf16 v[100:103], v[36:39], v[180:183], v[100:103]
    v_mov_b32 v156, 0
    v_mov_b32 v157, 0
    v_mov_b32 v158, 0
    v_mov_b32 v159, 0
    v_mfma_f32_16x16x32_bf16 v[104:107], v[36:39], v[184:187], v[104:107]
    v_xor_b32 v160, 16, v25
    v_add_u32 v160, 2048, v160
    v_mfma_f32_16x16x32_bf16 v[108:111], v[36:39], v[188:191], v[108:111]
    s_add_u32 m0, s31, 69632
    s_nop 0
    buffer_load_dwordx4 v13, s[68:71], s53 offen offset:0 sc1 lds
    buffer_load_dwordx2 v[76:77], v22, s[44:47], 0 offen
    buffer_load_dwordx2 v[78:79], v22, s[44:47], 0 offen offset:16
    buffer_load_dword v24, v24, s[72:75], 0 offen sc1
    s_waitcnt vmcnt(10)
    ds_read_b128 v[52:55], v27 offset:5120
    s_waitcnt lgkmcnt(3)
    v_mfma_f32_16x16x32_bf16 v[112:115], v[40:43], v[176:179], v[112:115]
    v_mfma_f32_16x16x32_bf16 v[116:119], v[40:43], v[180:183], v[116:119]
    v_mfma_f32_16x16x32_bf16 v[120:123], v[40:43], v[184:187], v[120:123]
    v_mfma_f32_16x16x32_bf16 v[124:127], v[40:43], v[188:191], v[124:127]
    s_add_u32 m0, s31, 70656
    s_nop 0
    buffer_load_dwordx4 v13, s[68:71], s54 offen offset:0 sc1 lds
    s_waitcnt vmcnt(10)
    ds_read_b128 v[56:59], v27 offset:6144
    s_waitcnt lgkmcnt(3)
    v_mfma_f32_16x16x32_bf16 v[128:131], v[44:47], v[176:179], v[128:131]
    v_mfma_f32_16x16x32_bf16 v[132:135], v[44:47], v[180:183], v[132:135]
    v_mfma_f32_16x16x32_bf16 v[136:139], v[44:47], v[184:187], v[136:139]
    v_mfma_f32_16x16x32_bf16 v[140:143], v[44:47], v[188:191], v[140:143]
    s_add_u32 m0, s31, 71424
    s_nop 0
    buffer_load_dwordx4 v13, s[68:71], s53 offen offset:256 sc1 lds
    s_waitcnt vmcnt(10)
    ds_read_b128 v[60:63], v27 offset:7168
    s_waitcnt lgkmcnt(3)
    v_mfma_f32_16x16x32_bf16 v[80:83], v[48:51], v[192:195], v[80:83]
    v_mfma_f32_16x16x32_bf16 v[84:87], v[48:51], v[196:199], v[84:87]
    v_mfma_f32_16x16x32_bf16 v[88:91], v[48:51], v[200:203], v[88:91]
    v_mfma_f32_16x16x32_bf16 v[92:95], v[48:51], v[204:207], v[92:95]
    s_add_u32 m0, s31, 72448
    s_nop 0
    buffer_load_dwordx4 v13, s[68:71], s54 offen offset:256 sc1 lds
    s_waitcnt vmcnt(10)
    ds_read_b128 v[32:35], v8 offset:0
    s_waitcnt lgkmcnt(3)
    v_mfma_f32_16x16x32_bf16 v[96:99], v[52:55], v[192:195], v[96:99]
    v_mfma_f32_16x16x32_bf16 v[100:103], v[52:55], v[196:199], v[100:103]
    v_mfma_f32_16x16x32_bf16 v[104:107], v[52:55], v[200:203], v[104:107]
    v_mfma_f32_16x16x32_bf16 v[108:111], v[52:55], v[204:207], v[108:111]
    s_add_u32 m0, s32, 0
    s_nop 0
    buffer_load_dwordx4 v29, s[68:71], s53 offen offset:0 sc1 lds
    s_waitcnt vmcnt(10)
    ds_read_b128 v[36:39], v8 offset:1024
    s_waitcnt lgkmcnt(3)
    v_mfma_f32_16x16x32_bf16 v[112:115], v[56:59], v[192:195], v[112:115]
    v_mfma_f32_16x16x32_bf16 v[116:119], v[56:59], v[196:199], v[116:119]
    v_mfma_f32_16x16x32_bf16 v[120:123], v[56:59], v[200:203], v[120:123]
    v_mfma_f32_16x16x32_bf16 v[124:127], v[56:59], v[204:207], v[124:127]
    s_add_u32 m0, s32, 1024
    s_nop 0
    buffer_load_dwordx4 v29, s[68:71], s54 offen offset:0 sc1 lds
    s_waitcnt vmcnt(10)
    ds_read_b128 v[40:43], v8 offset:2048
    s_waitcnt lgkmcnt(3)
    v_mfma_f32_16x16x32_bf16 v[128:131], v[60:63], v[192:195], v[128:131]
    v_mfma_f32_16x16x32_bf16 v[132:135], v[60:63], v[196:199], v[132:135]
    v_mfma_f32_16x16x32_bf16 v[136:139], v[60:63], v[200:203], v[136:139]
    v_mfma_f32_16x16x32_bf16 v[140:143], v[60:63], v[204:207], v[140:143]
    buffer_load_dwordx4 v[64:67], v29, s[68:71], s53 offen offset:256 sc1
    s_waitcnt vmcnt(10)
    ds_read_b128 v[44:47], v8 offset:3072
    s_waitcnt lgkmcnt(3)
    v_mfma_f32_16x16x32_bf16 v[80:83], v[32:35], v[208:211], v[80:83]
    v_mfma_f32_16x16x32_bf16 v[84:87], v[32:35], v[212:215], v[84:87]
    v_mfma_f32_16x16x32_bf16 v[88:91], v[32:35], v[216:219], v[88:91]
    v_mfma_f32_16x16x32_bf16 v[92:95], v[32:35], v[220:223], v[92:95]
    buffer_load_dwordx4 v[68:71], v29, s[68:71], s54 offen offset:256 sc1
    s_waitcnt vmcnt(10)
    ds_read_b128 v[48:51], v8 offset:4096
    s_waitcnt lgkmcnt(3)
    v_mfma_f32_16x16x32_bf16 v[96:99], v[36:39], v[208:211], v[96:99]
    v_mfma_f32_16x16x32_bf16 v[100:103], v[36:39], v[212:215], v[100:103]
    v_mfma_f32_16x16x32_bf16 v[104:107], v[36:39], v[216:219], v[104:107]
    v_mfma_f32_16x16x32_bf16 v[108:111], v[36:39], v[220:223], v[108:111]
    buffer_load_dwordx2 v[6:7], v19, s[72:75], 0 offen sc1
    s_waitcnt vmcnt(7)
    ds_read_b128 v[52:55], v8 offset:5120
    s_waitcnt lgkmcnt(3)
    v_mfma_f32_16x16x32_bf16 v[112:115], v[40:43], v[208:211], v[112:115]
    v_mfma_f32_16x16x32_bf16 v[116:119], v[40:43], v[212:215], v[116:119]
    v_mfma_f32_16x16x32_bf16 v[120:123], v[40:43], v[216:219], v[120:123]
    v_mfma_f32_16x16x32_bf16 v[124:127], v[40:43], v[220:223], v[124:127]
    s_waitcnt vmcnt(6)
    ds_read_b128 v[56:59], v8 offset:6144
    s_waitcnt lgkmcnt(3)
    v_mfma_f32_16x16x32_bf16 v[128:131], v[44:47], v[208:211], v[128:131]
    v_mfma_f32_16x16x32_bf16 v[132:135], v[44:47], v[212:215], v[132:135]
    v_mfma_f32_16x16x32_bf16 v[136:139], v[44:47], v[216:219], v[136:139]
    v_mfma_f32_16x16x32_bf16 v[140:143], v[44:47], v[220:223], v[140:143]
    s_waitcnt vmcnt(5)
    ds_read_b128 v[60:63], v8 offset:7168
    s_waitcnt lgkmcnt(3)
    v_mfma_f32_16x16x32_bf16 v[80:83], v[48:51], v[224:227], v[80:83]
    v_mfma_f32_16x16x32_bf16 v[84:87], v[48:51], v[228:231], v[84:87]
    v_mfma_f32_16x16x32_bf16 v[88:91], v[48:51], v[232:235], v[88:91]
    v_mfma_f32_16x16x32_bf16 v[92:95], v[48:51], v[236:239], v[92:95]
    s_waitcnt vmcnt(4)
    ds_read_b128 v[32:35], v14 offset:0
    s_waitcnt lgkmcnt(3)
    v_mfma_f32_16x16x32_bf16 v[80:83], v[52:55], v[240:243], v[80:83]
    v_mfma_f32_16x16x32_bf16 v[84:87], v[52:55], v[244:247], v[84:87]
    v_mfma_f32_16x16x32_bf16 v[88:91], v[52:55], v[248:251], v[88:91]
    v_mfma_f32_16x16x32_bf16 v[92:95], v[52:55], v[252:255], v[92:95]
    s_waitcnt vmcnt(3)
    ds_read_b128 v[36:39], v14 offset:1024
    s_waitcnt lgkmcnt(3)
    v_mfma_f32_16x16x32_bf16 v[96:99], v[56:59], v[224:227], v[96:99]
    v_mfma_f32_16x16x32_bf16 v[100:103], v[56:59], v[228:231], v[100:103]
    v_mfma_f32_16x16x32_bf16 v[104:107], v[56:59], v[232:235], v[104:107]
    s_add_u32 m0, s31, 0
    s_nop 0
    ds_write_addtid_b32 v80 offset:0
    ds_write_addtid_b32 v81 offset:1024
    v_mfma_f32_16x16x32_bf16 v[108:111], v[56:59], v[236:239], v[108:111]
    ds_write_addtid_b32 v82 offset:2048
    ds_write_addtid_b32 v83 offset:3072
    s_waitcnt vmcnt(0)
    v_cmp_ne_u64 s[40:41], s[96:97], v[6:7]
    s_mov_b32 s36, 0
    s_cmp_lg_u64 s[40:41], 0
    s_cbranch_scc1 L_ycs_21
    s_mov_b32 s36, 1
    buffer_load_dwordx4 v[72:75], v20, s[72:75], s34 offen sc1
L_ycs_21:
    s_waitcnt lgkmcnt(6)
    v_mfma_f32_16x16x32_bf16 v[96:99], v[60:63], v[240:243], v[96:99]
    ds_write_addtid_b32 v84 offset:256
    ds_write_addtid_b32 v85 offset:1280
    v_mfma_f32_16x16x32_bf16 v[100:103], v[60:63], v[244:247], v[100:103]
    ds_write_addtid_b32 v86 offset:2304
    ds_write_addtid_b32 v87 offset:3328
    v_mfma_f32_16x16x32_bf16 v[104:107], v[60:63], v[248:251], v[104:107]
    ds_write_addtid_b32 v88 offset:512
    ds_write_addtid_b32 v89 offset:1536
    v_mfma_f32_16x16x32_bf16 v[108:111], v[60:63], v[252:255], v[108:111]
    ds_write_addtid_b32 v90 offset:2560
    ds_write_addtid_b32 v91 offset:3584
    s_waitcnt lgkmcnt(13)
    v_mfma_f32_16x16x32_bf16 v[112:115], v[32:35], v[224:227], v[112:115]
    ds_write_addtid_b32 v92 offset:768
    ds_write_addtid_b32 v93 offset:1792
    v_mfma_f32_16x16x32_bf16 v[116:119], v[32:35], v[228:231], v[116:119]
    ds_write_addtid_b32 v94 offset:2816
    ds_write_addtid_b32 v95 offset:3840
    v_mfma_f32_16x16x32_bf16 v[120:123], v[32:35], v[232:235], v[120:123]
    ds_write_addtid_b32 v96 offset:4096
    ds_write_addtid_b32 v97 offset:5120
    v_mfma_f32_16x16x32_bf16 v[124:127], v[32:35], v[236:239], v[124:127]
    ds_write_addtid_b32 v98 offset:6144
    ds_write_addtid_b32 v99 offset:7168
    s_waitcnt lgkmcnt(15)
    v_mfma_f32_16x16x32_bf16 v[112:115], v[36:39], v[240:243], v[112:115]
    ds_write_addtid_b32 v100 offset:4352
    ds_write_addtid_b32 v101 offset:5376
    v_mfma_f32_16x16x32_bf16 v[116:119], v[36:39], v[244:247], v[116:119]
    ds_write_addtid_b32 v102 offset:6400
    ds_write_addtid_b32 v103 offset:7424
    v_mfma_f32_16x16x32_bf16 v[120:123], v[36:39], v[248:251], v[120:123]
    ds_write_addtid_b32 v104 offset:4608
    ds_write_addtid_b32 v105 offset:5632
    v_mfma_f32_16x16x32_bf16 v[124:127], v[36:39], v[252:255], v[124:127]
    ds_write_addtid_b32 v106 offset:6656
    ds_write_addtid_b32 v107 offset:7680
    v_mfma_f32_16x16x32_bf16 v[128:131], v[64:67], v[224:227], v[128:131]
    ds_write_addtid_b32 v108 offset:4864
    ds_write_addtid_b32 v109 offset:5888
    v_mfma_f32_16x16x32_bf16 v[132:135], v[64:67], v[228:231], v[132:135]
    ds_write_addtid_b32 v110 offset:6912
    ds_write_addtid_b32 v111 offset:7936
    v_mfma_f32_16x16x32_bf16 v[136:139], v[64:67], v[232:235], v[136:139]
    s_add_u32 m0, s31, 7940
    s_nop 0
    ds_write_addtid_b32 v112 offset:57596
    ds_write_addtid_b32 v113 offset:58620
    v_mfma_f32_16x16x32_bf16 v[140:143], v[64:67], v[236:239], v[140:143]
    ds_write_addtid_b32 v114 offset:59644
    ds_write_addtid_b32 v115 offset:60668
    v_mfma_f32_16x16x32_bf16 v[128:131], v[68:71], v[240:243], v[128:131]
    ds_write_addtid_b32 v116 offset:57852
    ds_write_addtid_b32 v117 offset:58876
    v_mfma_f32_16x16x32_bf16 v[132:135], v[68:71], v[244:247], v[132:135]
    ds_write_addtid_b32 v118 offset:59900
    ds_write_addtid_b32 v119 offset:60924
    v_mfma_f32_16x16x32_bf16 v[136:139], v[68:71], v[248:251], v[136:139]
    ds_write_addtid_b32 v120 offset:58108
    ds_write_addtid_b32 v121 offset:59132
    v_mfma_f32_16x16x32_bf16 v[140:143], v[68:71], v[252:255], v[140:143]
    ds_write_addtid_b32 v122 offset:60156
    ds_write_addtid_b32 v123 offset:61180
    s_cmp_lg_u32 s36, 0
    s_cbranch_scc1 L_yok_22
    v_cmp_ne_u64 s[40:41], s[96:97], v[6:7]
    s_cmp_lg_u64 s[40:41], 0
    s_cbranch_scc0 L_pok_23
L_pre_24:
    s_cmp_eq_u32 s19, 0
    s_cbranch_scc1 L_pok_23
    s_sub_u32 s19, s19, 1
    s_sleep 2
    buffer_load_dwordx2 v[6:7], v19, s[72:75], 0 offen sc1
    s_waitcnt vmcnt(0)
    v_cmp_ne_u64 s[40:41], s[96:97], v[6:7]
    s_cmp_lg_u64 s[40:41], 0
    s_cbranch_scc1 L_pre_24
L_pok_23:
    buffer_load_dwordx4 v[72:75], v20, s[72:75], s34 offen sc1
L_yok_22:
    s_nop 3
    ds_write_addtid_b32 v124 offset:58364
    ds_write_addtid_b32 v125 offset:59388
    ds_write_addtid_b32 v126 offset:60412
    ds_write_addtid_b32 v127 offset:61436
    ds_write_addtid_b32 v128 offset:61692
    ds_write_addtid_b32 v129 offset:62716
    ds_write_addtid_b32 v130 offset:63740
    ds_write_addtid_b32 v131 offset:64764
    ds_write_addtid_b32 v132 offset:61948
    ds_write_addtid_b32 v133 offset:62972
    ds_write_addtid_b32 v134 offset:63996
    ds_write_addtid_b32 v135 offset:65020
    ds_write_addtid_b32 v136 offset:62204
    ds_write_addtid_b32 v137 offset:63228
    ds_write_addtid_b32 v138 offset:64252
    ds_write_addtid_b32 v139 offset:65276
    ds_write_addtid_b32 v140 offset:62460
    ds_write_addtid_b32 v141 offset:63484
    ds_write_addtid_b32 v142 offset:64508
    ds_write_addtid_b32 v143 offset:65532
    v_sub_f32 v2, 1.0, v24
    v_cvt_pk_bf16_f32 v2, v2, v2
    v_lshlrev_b32 v2, 16, v2
    v_lshlrev_b32 v144, 16, v76
    v_and_b32 v145, 0xffff0000, v76
    v_lshlrev_b32 v146, 16, v77
    v_and_b32 v147, 0xffff0000, v77
    v_lshlrev_b32 v148, 16, v78
    v_and_b32 v149, 0xffff0000, v78
    v_lshlrev_b32 v150, 16, v79
    v_and_b32 v151, 0xffff0000, v79
    s_waitcnt vmcnt(0)
    ds_write_b128 v21, v[72:75]
    s_waitcnt lgkmcnt(0)
    s_barrier
    ds_read_u16_d16_hi v152, v25 offset:0
    ds_read_u16_d16_hi v153, v25 offset:128
    ds_read_u16_d16_hi v154, v25 offset:256
    ds_read_u16_d16_hi v155, v25 offset:384
    ds_read_u16_d16_hi v156, v160 offset:0
    ds_read_u16_d16_hi v157, v160 offset:128
    ds_read_u16_d16_hi v158, v160 offset:256
    ds_read_u16_d16_hi v159, v160 offset:384
    ds_read_b64 v[80:81], v26 offset:0
    ds_read_b64 v[82:83], v26 offset:256
    ds_read_b64 v[84:85], v26 offset:512
    ds_read_b64 v[86:87], v26 offset:768
    ds_read_b64 v[88:89], v26 offset:8192
    ds_read_b64 v[90:91], v26 offset:8448
    ds_read_b64 v[92:93], v26 offset:8704
    ds_read_b64 v[94:95], v26 offset:8960
    s_waitcnt lgkmcnt(8)
    v_mul_f32 v144, v144, v152
    v_mul_f32 v145, v145, v153
    v_mul_f32 v146, v146, v154
    v_mul_f32 v147, v147, v155
    v_mul_f32 v148, v148, v156
    v_mul_f32 v149, v149, v157
    v_mul_f32 v150, v150, v158
    v_mul_f32 v151, v151, v159
    v_mul_f32 v144, v144, v24
    v_mul_f32 v145, v145, v24
    v_mul_f32 v146, v146, v24
    v_mul_f32 v147, v147, v24
    v_mul_f32 v148, v148, v24
    v_mul_f32 v149, v149, v24
    v_mul_f32 v150, v150, v24
    v_mul_f32 v151, v151, v24
    ds_read_b64 v[96:97], v26 offset:16384
    ds_read_b64 v[98:99], v26 offset:16640
    ds_read_b64 v[100:101], v26 offset:16896
    ds_read_b64 v[102:103], v26 offset:17152
    ds_read_b64 v[104:105], v26 offset:24576
    ds_read_b64 v[106:107], v26 offset:24832
    ds_read_b64 v[108:109], v26 offset:25088
    ds_read_b64 v[110:111], v26 offset:25344
    s_waitcnt lgkmcnt(8)
    v_pk_add_f32 v[80:81], v[80:81], v[88:89]
    v_pk_add_f32 v[82:83], v[82:83], v[90:91]
    v_pk_add_f32 v[84:85], v[84:85], v[92:93]
    v_pk_add_f32 v[86:87], v[86:87], v[94:95]
    ds_read_b64 v[112:113], v26 offset:32768
    ds_read_b64 v[114:115], v26 offset:33024
    ds_read_b64 v[116:117], v26 offset:33280
    ds_read_b64 v[118:119], v26 offset:33536
    s_waitcnt lgkmcnt(8)
    v_pk_add_f32 v[80:81], v[80:81], v[96:97]
    v_pk_add_f32 v[82:83], v[82:83], v[98:99]
    v_pk_add_f32 v[84:85], v[84:85], v[100:101]
    v_pk_add_f32 v[86:87], v[86:87], v[102:103]
    ds_read_b64 v[120:121], v26 offset:40960
    ds_read_b64 v[122:123], v26 offset:41216
    ds_read_b64 v[124:125], v26 offset:41472
    ds_read_b64 v[126:127], v26 offset:41728
    s_waitcnt lgkmcnt(8)
    v_pk_add_f32 v[80:81], v[80:81], v[104:105]
    v_pk_add_f32 v[82:83], v[82:83], v[106:107]
    v_pk_add_f32 v[84:85], v[84:85], v[108:109]
    v_pk_add_f32 v[86:87], v[86:87], v[110:111]
    ds_read_b64 v[128:129], v26 offset:49152
    ds_read_b64 v[130:131], v26 offset:49408
    ds_read_b64 v[132:133], v26 offset:49664
    ds_read_b64 v[134:135], v26 offset:49920
    s_waitcnt lgkmcnt(8)
    v_pk_add_f32 v[80:81], v[80:81], v[112:113]
    v_pk_add_f32 v[82:83], v[82:83], v[114:115]
    v_pk_add_f32 v[84:85], v[84:85], v[116:117]
    v_pk_add_f32 v[86:87], v[86:87], v[118:119]
    ds_read_b64 v[136:137], v26 offset:57344
    ds_read_b64 v[138:139], v26 offset:57600
    ds_read_b64 v[140:141], v26 offset:57856
    ds_read_b64 v[142:143], v26 offset:58112
    s_waitcnt lgkmcnt(8)
    v_pk_add_f32 v[80:81], v[80:81], v[120:121]
    v_pk_add_f32 v[82:83], v[82:83], v[122:123]
    v_pk_add_f32 v[84:85], v[84:85], v[124:125]
    v_pk_add_f32 v[86:87], v[86:87], v[126:127]
    s_waitcnt lgkmcnt(4)
    v_pk_add_f32 v[80:81], v[80:81], v[128:129]
    v_pk_add_f32 v[82:83], v[82:83], v[130:131]
    v_pk_add_f32 v[84:85], v[84:85], v[132:133]
    v_pk_add_f32 v[86:87], v[86:87], v[134:135]
    s_waitcnt lgkmcnt(0)
    v_pk_add_f32 v[80:81], v[80:81], v[136:137]
    v_pk_add_f32 v[82:83], v[82:83], v[138:139]
    v_pk_add_f32 v[84:85], v[84:85], v[140:141]
    v_pk_add_f32 v[86:87], v[86:87], v[142:143]
    v_fmac_f32 v144, v2, v80
    v_fmac_f32 v145, v2, v82
    v_fmac_f32 v146, v2, v84
    v_fmac_f32 v147, v2, v86
    v_fmac_f32 v148, v2, v81
    v_fmac_f32 v149, v2, v83
    v_fmac_f32 v150, v2, v85
    v_fmac_f32 v151, v2, v87
    v_cvt_pk_bf16_f32 v76, v144, v145
    v_cvt_pk_bf16_f32 v77, v146, v147
    v_cvt_pk_bf16_f32 v78, v148, v149
    v_cvt_pk_bf16_f32 v79, v150, v151
    buffer_store_dwordx2 v[76:77], v22, s[84:87], 0 offen
    buffer_store_dwordx2 v[78:79], v22, s[84:87], 0 offen offset:16
L_end:
    s_endpgm
L_helper:
    s_sub_u32 s9, s2, 224
    s_and_b32 s8, s9, 7
    s_lshl_b32 s8, s8, 2
    s_lshr_b32 s9, s9, 3
    s_add_u32 s9, s9, s8
    s_lshl_b32 s8, s9, 3
    s_add_u32 s8, s8, s3
    v_lshlrev_b32 v8, 4, v0
    s_mul_i32 s7, s9, 50176
    v_lshrrev_b32 v2, 5, v1
    s_lshl_b32 s4, s8, 3
    v_add_u32 v9, s4, v2
    v_mul_u32_u24 v2, 896, v9
    v_and_b32 v3, 31, v1
    v_lshlrev_b32 v4, 4, v3
    v_cmp_gt_u32 vcc, 28, v3
    v_add_u32 v2, v2, v4
    v_mov_b32 v7, 2147418112
    v_cndmask_b32 v10, v7, v2, vcc
    v_cndmask_b32 v11, v7, v4, vcc
    v_lshlrev_b32 v12, 20, v1
    s_waitcnt lgkmcnt(0)
    s_mov_b32 s80, s34
    s_and_b32 s81, s35, 0xffff
    s_mov_b32 s82, 1605632
    s_mov_b32 s83, 0x00020000
    s_mov_b32 s72, s42
    s_and_b32 s73, s43, 0xffff
    s_mov_b32 s74, 33554432
    s_mov_b32 s75, 0x00020000
    s_mov_b32 s84, s38
    s_and_b32 s85, s39, 0xffff
    s_mov_b32 s86, 1835008
    s_mov_b32 s87, 0x00020000
    s_mov_b32 s76, s24
    s_and_b32 s77, s25, 0xffff
    s_mov_b32 s78, 1835008
    s_mov_b32 s79, 0x00020000
    buffer_load_dword v13, v12, s[72:75], 0 offen
    buffer_load_dword v14, v12, s[84:87], 0 offen
    buffer_load_dword v15, v12, s[76:79], 0 offen
    buffer_load_dwordx4 v[32:35], v8, s[80:83], s7 offen
    s_add_u32 s7, s7, 8192
    buffer_load_dwordx4 v[36:39], v8, s[80:83], s7 offen
    s_add_u32 s7, s7, 8192
    buffer_load_dwordx4 v[40:43], v8, s[80:83], s7 offen
    s_add_u32 s7, s7, 8192
    buffer_load_dwordx4 v[44:47], v8, s[80:83], s7 offen
    s_add_u32 s7, s7, 8192
    buffer_load_dwordx4 v[48:51], v8, s[80:83], s7 offen
    s_add_u32 s7, s7, 8192
    buffer_load_dwordx4 v[52:55], v8, s[80:83], s7 offen
    s_add_u32 s7, s7, 8192
    buffer_load_dwordx4 v[56:59], v8, s[80:83], s7 offen
    s_add_u32 s7, s7, 8192
    s_mov_b32 s44, s16
    s_and_b32 s45, s17, 0xffff
    s_mov_b32 s46, 1835008
    s_mov_b32 s47, 0x00020000
    s_mov_b32 s68, s36
    s_and_b32 s69, s37, 0xffff
    s_mov_b32 s70, 896
    s_mov_b32 s71, 0x00020000
    s_mov_b32 s88, s40
    s_and_b32 s89, s41, 0xffff
    s_mov_b32 s90, 256
    s_mov_b32 s91, 0x00020000
    s_mov_b32 s19, 20000
    buffer_load_dwordx4 v[96:99], v11, s[68:71], 0 offen
    buffer_load_dwordx4 v[100:103], v11, s[68:71], 0 offen offset:448
    s_mov_b32 s4, 0
    buffer_load_dwordx4 v[64:67], v10, s[44:47], s4 offen
    buffer_load_dwordx4 v[68:71], v10, s[44:47], s4 offen offset:448
    s_mov_b32 s4, 1792
    buffer_load_dwordx4 v[72:75], v10, s[44:47], s4 offen
    buffer_load_dwordx4 v[76:79], v10, s[44:47], s4 offen offset:448
    s_mov_b32 s4, 3584
    buffer_load_dwordx4 v[80:83], v10, s[44:47], s4 offen
    buffer_load_dwordx4 v[84:87], v10, s[44:47], s4 offen offset:448
    s_mov_b32 s4, 5376
    buffer_load_dwordx4 v[88:91], v10, s[44:47], s4 offen
    buffer_load_dwordx4 v[92:95], v10, s[44:47], s4 offen offset:448
    buffer_load_dwordx2 v[30:31], off, s[88:91], 0 sc1
    v_cmp_gt_u32 vcc, 16, v1
    v_mov_b32 v4, 2147418112
    v_lshlrev_b32 v5, 3, v1
    v_cndmask_b32 v28, v4, v5, vcc
    s_lshl_b32 s5, s8, 7
    s_add_u32 s23, s5, 16515072
    buffer_load_dword v16, off, s[72:75], s23 sc1
    v_lshl_add_u32 v2, v3, 1, v9
    v_lshlrev_b32 v2, 2, v2
    v_add_u32 v2, 12582912, v2
    v_cmp_gt_u32 vcc, 4, v3
    s_nop 1
    v_cndmask_b32 v17, v7, v2, vcc
    buffer_load_dword v18, v17, s[72:75], 0 offen sc1
    s_waitcnt vmcnt(3)
    v_dot2_f32_bf16 v104, v64, v96, 0
    v_dot2_f32_bf16 v105, v65, v97, 0
    v_dot2_f32_bf16 v106, v66, v98, 0
    v_dot2_f32_bf16 v107, v67, v99, 0
    v_dot2_f32_bf16 v108, v72, v96, 0
    v_dot2_f32_bf16 v109, v73, v97, 0
    v_dot2_f32_bf16 v110, v74, v98, 0
    v_dot2_f32_bf16 v111, v75, v99, 0
    v_dot2_f32_bf16 v112, v80, v96, 0
    v_dot2_f32_bf16 v113, v81, v97, 0
    v_dot2_f32_bf16 v114, v82, v98, 0
    v_dot2_f32_bf16 v115, v83, v99, 0
    v_dot2_f32_bf16 v116, v88, v96, 0
    v_dot2_f32_bf16 v117, v89, v97, 0
    v_dot2_f32_bf16 v118, v90, v98, 0
    v_dot2_f32_bf16 v119, v91, v99, 0
    v_dot2_f32_bf16 v104, v68, v100, v104
    v_dot2_f32_bf16 v105, v69, v101, v105
    v_dot2_f32_bf16 v106, v70, v102, v106
    v_dot2_f32_bf16 v107, v71, v103, v107
    v_dot2_f32_bf16 v108, v76, v100, v108
    v_dot2_f32_bf16 v109, v77, v101, v109
    v_dot2_f32_bf16 v110, v78, v102, v110
    v_dot2_f32_bf16 v111, v79, v103, v111
    v_dot2_f32_bf16 v112, v84, v100, v112
    v_dot2_f32_bf16 v113, v85, v101, v113
    v_dot2_f32_bf16 v114, v86, v102, v114
    v_dot2_f32_bf16 v115, v87, v103, v115
    v_dot2_f32_bf16 v116, v92, v100, v116
    v_dot2_f32_bf16 v117, v93, v101, v117
    v_dot2_f32_bf16 v118, v94, v102, v118
    v_dot2_f32_bf16 v119, v95, v103, v119
    s_nop 2
    v_add_f32 v104, v104, v105
    v_add_f32 v106, v106, v107
    v_add_f32 v108, v108, v109
    v_add_f32 v110, v110, v111
    v_add_f32 v112, v112, v113
    v_add_f32 v114, v114, v115
    v_add_f32 v116, v116, v117
    v_add_f32 v118, v118, v119
    v_add_f32 v104, v104, v106
    v_add_f32 v108, v108, v110
    v_add_f32 v112, v112, v114
    v_add_f32 v116, v116, v118
    v_add_f32_dpp v104, v104, v104 quad_perm:[1,0,3,2] row_mask:0xf bank_mask:0xf
    v_add_f32_dpp v108, v108, v108 quad_perm:[1,0,3,2] row_mask:0xf bank_mask:0xf
    v_add_f32_dpp v112, v112, v112 quad_perm:[1,0,3,2] row_mask:0xf bank_mask:0xf
    v_add_f32_dpp v116, v116, v116 quad_perm:[1,0,3,2] row_mask:0xf bank_mask:0xf
    v_add_f32_dpp v104, v104, v104 quad_perm:[2,3,0,1] row_mask:0xf bank_mask:0xf
    v_add_f32_dpp v108, v108, v108 quad_perm:[2,3,0,1] row_mask:0xf bank_mask:0xf
    v_add_f32_dpp v112, v112, v112 quad_perm:[2,3,0,1] row_mask:0xf bank_mask:0xf
    v_add_f32_dpp v116, v116, v116 quad_perm:[2,3,0,1] row_mask:0xf bank_mask:0xf
    v_add_f32_dpp v104, v104, v104 row_half_mirror row_mask:0xf bank_mask:0xf
    v_add_f32_dpp v108, v108, v108 row_half_mirror row_mask:0xf bank_mask:0xf
    v_add_f32_dpp v112, v112, v112 row_half_mirror row_mask:0xf bank_mask:0xf
    v_add_f32_dpp v116, v116, v116 row_half_mirror row_mask:0xf bank_mask:0xf
    v_add_f32_dpp v104, v104, v104 row_mirror row_mask:0xf bank_mask:0xf
    v_add_f32_dpp v108, v108, v108 row_mirror row_mask:0xf bank_mask:0xf
    v_add_f32_dpp v112, v112, v112 row_mirror row_mask:0xf bank_mask:0xf
    v_add_f32_dpp v116, v116, v116 row_mirror row_mask:0xf bank_mask:0xf
    v_mov_b32 v105, v104
    v_mov_b32 v109, v108
    v_mov_b32 v113, v112
    v_mov_b32 v117, v116
    s_nop 1
    v_permlane16_swap_b32 v104, v105
    v_permlane16_swap_b32 v108, v109
    v_permlane16_swap_b32 v112, v113
    v_permlane16_swap_b32 v116, v117
    s_nop 1
    v_add_f32 v104, v104, v105
    v_add_f32 v108, v108, v109
    v_add_f32 v112, v112, v113
    v_add_f32 v116, v116, v117
    v_cmp_eq_u32 vcc, 1, v3
    s_nop 1
    v_cndmask_b32 v104, v104, v108, vcc
    v_cmp_eq_u32 vcc, 2, v3
    s_nop 1
    v_cndmask_b32 v104, v104, v112, vcc
    v_cmp_eq_u32 vcc, 3, v3
    s_nop 1
    v_cndmask_b32 v104, v104, v116, vcc
    v_cvt_pk_bf16_f32 v104, v104, v104
    v_lshlrev_b32 v104, 16, v104
    v_mul_f32 v104, 0xbfb8aa3b, v104
    v_exp_f32 v104, v104
    s_nop 0
    v_add_f32 v104, 1.0, v104
    v_rcp_f32 v104, v104
    s_nop 0
    v_cvt_pk_bf16_f32 v104, v104, v104
    v_lshlrev_b32 v104, 16, v104
    buffer_store_dword v104, v17, s[72:75], 0 offen sc1
    s_waitcnt vmcnt(3)
    v_readfirstlane_b32 s96, v30
    v_readfirstlane_b32 s97, v31
    s_cmp_lg_u32 s96, 0
    s_cbranch_scc1 L_nok_25
L_nre_26:
    s_cmp_eq_u32 s19, 0
    s_cbranch_scc1 L_nok_25
    s_sub_u32 s19, s19, 1
    s_sleep 2
    buffer_load_dwordx2 v[30:31], off, s[88:91], 0 sc1
    s_waitcnt vmcnt(0)
    v_readfirstlane_b32 s96, v30
    v_readfirstlane_b32 s97, v31
    s_cmp_eq_u32 s96, 0
    s_cbranch_scc1 L_nre_26
L_nok_25:
    s_waitcnt vmcnt(0)
    buffer_store_dwordx2 v[30:31], v28, s[72:75], s23 offen sc1
    s_endpgm
L_codeend:
.section .rodata,"a"
.p2align 6
.amdhsa_kernel gated_mix__ssm_conv_h3__dense_activation_mish__prompt_kernel
  .amdhsa_next_free_vgpr 256
  .amdhsa_next_free_sgpr 102
  .amdhsa_accum_offset 256
  .amdhsa_group_segment_fixed_size 0
  .amdhsa_kernarg_size 112
  .amdhsa_user_sgpr_count 2
  .amdhsa_user_sgpr_kernarg_segment_ptr 1
  .amdhsa_system_sgpr_workgroup_id_x 1
  .amdhsa_float_denorm_mode_32 3
.end_amdhsa_kernel
```
